```python
import torch

def _softmax(x, axis=-1):
    return torch.softmax(x, dim=axis)

def _gelu(x):
    return torch.nn.functional.gelu(x, approximate='tanh')

def _silu(x):
    return torch.nn.functional.silu(x)

def _sigmoid(x):
    return torch.sigmoid(x)

def _layernorm(x, axis=-1, eps=1e-05):
    m = x.mean(dim=axis, keepdim=True)
    v = x.var(dim=axis, keepdim=True, unbiased=False)
    return (x - m) / torch.sqrt(v + eps)

def _scatter_add(tgt, idx, src, axis=0):
    return tgt.clone().index_add_(axis, idx, src)

def _segment_sum(src, seg, n):
    out = torch.zeros((n,) + src.shape[1:], dtype=src.dtype)
    return out.index_add_(0, seg, src)

def _pad(x, pw):
    flat = tuple((v for pair in reversed(pw) for v in pair))
    return torch.nn.functional.pad(x, flat)
kernel_name = 'gather_scatter__tensor_product_equiv_tfn__graph'

def setup_inputs():

    _w = lambda a: (lambda t: t.to(torch.bfloat16) if t.is_floating_point() else t)(torch.as_tensor(a))
    N, deg, C, L, DE = (10000, 16, 128, 1, 16)
    E = N * deg
    M = (L + 1) ** 2
    src = (lambda lo, hi, *s: torch.randint(lo, hi, s))(0, N, E).to(torch.int64)
    dst = (lambda lo, hi, *s: torch.randint(lo, hi, s))(0, N, E).to(torch.int64)
    r = (lambda *s: torch.randn(*s, dtype=torch.bfloat16) * 0.05)(E, 3)
    r = r / (torch.linalg.norm(r, dim=-1, keepdim=True) + 1e-09)
    rx, ry, rz = (r[:, 0].clone(), r[:, 1].clone(), r[:, 2].clone())
    Ys = [torch.ones((E, 1), dtype=float)]
    if L >= 1:
        Ys.append(r.to(float))
    if L >= 2:
        Ys.append(torch.stack([2 * rx * ry, 2 * ry * rz, (3 * rz * rz - 1.0) / (lambda _x: torch.sqrt(torch.as_tensor(_x)))(3.0), 2 * rx * rz, rx * rx - ry * ry], dim=-1).to(float))
    for _l in range(3, L + 1):
        Ys.append(((lambda *s: torch.randn(*s, dtype=torch.bfloat16) * 0.05)(E, 2 * _l + 1) * 0.3).to(float))
    Y = torch.cat(Ys, dim=-1)
    cg = torch.zeros((M, M, M), dtype=float)
    off = [_l * _l for _l in range(L + 2)]
    for l1 in range(L + 1):
        for l2 in range(L + 1):
            for l3 in range(abs(l1 - l2), min(L, l1 + l2) + 1):
                d1, d2, d3 = (2 * l1 + 1, 2 * l2 + 1, 2 * l3 + 1)
                cg[off[l1]:off[l1 + 1], off[l2]:off[l2 + 1], off[l3]:off[l3 + 1]] = (lambda *s: torch.randn(*s, dtype=torch.bfloat16) * 0.05)(d1, d2, d3) / (lambda _x: torch.sqrt(torch.as_tensor(_x)))(float(d1 * d2))
    return {'x': _w((lambda *s: torch.randn(*s, dtype=torch.bfloat16) * 0.05)(N, C, M) * 0.2), 'src': _w(src), 'dst': _w(dst), 'Y': _w(Y), 'edge_feat': _w((lambda *s: torch.randn(*s, dtype=torch.bfloat16) * 0.05)(E, DE)), 'w_rad': _w((lambda *s: torch.randn(*s, dtype=torch.bfloat16) * 0.05)(DE, C) * (1.0 / max(1.0, DE) ** 0.5)), 'cg': _w(cg), 'w_mix': _w((lambda *s: torch.randn(*s, dtype=torch.bfloat16) * 0.05)(C, C) * (1.0 / max(1.0, C) ** 0.5))}

def reference(x, src, dst, Y, edge_feat, w_rad, cg, w_mix):
    N, C, M = (x.shape[0], x.shape[1], x.shape[2])
    R = _silu(edge_feat @ w_rad)
    xs = x[src]
    tp = torch.einsum('eci,ef,ifo->eco', xs, Y, cg)
    msg = R[:, :, None] * tp
    agg = _segment_sum(msg.reshape(-1, C * M), dst, N).reshape(N, C, M)
    return torch.einsum('ncm,cd->ndm', agg, w_mix)
```

```asm
; @launch kernel=bin_edges_kernel grid=(250,1,1) block=(320,1,1) lds=12288
; @launch kernel=gather_scatter__tensor_product_equiv_tfn__graph_kernel grid=(256,1,1) block=(512,1,1) lds=153856
.amdgcn_target "amdgcn-amd-amdhsa--gfx950"
.text
.globl bin_edges_kernel
.p2align 8
.type bin_edges_kernel,@function
bin_edges_kernel:
  s_cmp_ge_u32 s2, 250
  s_cbranch_scc1 L1_end
  s_load_dwordx4 s[4:7], s[0:1], 8
  s_load_dwordx2 s[8:9], s[0:1], 24
  s_load_dwordx2 s[40:41], s[0:1], 80
  v_lshlrev_b32 v1, 2, v0
  v_mov_b32 v2, 0
  v_lshrrev_b32 v21, 6, v0
  v_cmp_gt_u32 vcc, 256, v0
  s_and_saveexec_b64 s[12:13], vcc
  ds_write_b32 v1, v2 offset:0
  s_mov_b64 exec, s[12:13]
  s_mul_i32 s14, s2, 640
  v_lshl_add_u32 v3, v0, 1, s14
  v_readfirstlane_b32 s15, v21
  v_lshlrev_b32 v4, 2, v3
  v_lshlrev_b32 v5, 3, v3
  v_and_b32 v22, 63, v0
  v_lshlrev_b32 v22, 4, v22
  s_waitcnt lgkmcnt(0)
  s_mov_b32 s20, s6
  s_mov_b32 s21, s7
  s_mov_b32 s22, 640000
  s_mov_b32 s23, 0x20000
  buffer_load_dwordx2 v[6:7], v4, s[20:23], 0 offen sc0 sc1 nt
  s_mov_b32 s16, s4
  s_mov_b32 s17, s5
  s_mov_b32 s18, 640000
  s_mov_b32 s19, 0x20000
  buffer_load_dwordx2 v[24:25], v4, s[16:19], 0 offen sc0 sc1 nt
  s_mov_b32 s24, s8
  s_mov_b32 s25, s9
  s_mov_b32 s26, 1280000
  s_mov_b32 s27, 0x20000
  buffer_load_dwordx4 v[28:31], v5, s[24:27], 0 offen sc0 sc1 nt
  s_mov_b32 s28, s40
  s_mov_b32 s29, s41
  s_mov_b32 s30, 7942144
  s_mov_b32 s31, 0x20000
  s_lshr_b32 s34, s2, 3
  s_cmp_ge_u32 s34, 16
  s_cbranch_scc1 L1_nocode
  s_cmp_lg_u32 s15, 4
  s_cbranch_scc1 L1_nocode
  s_getpc_b64 s[62:63]
L1_pc:
  s_add_u32 s62, s62, gather_scatter__tensor_product_equiv_tfn__graph_kernel-L1_pc
  s_addc_u32 s63, s63, 0
  s_lshl_b32 s34, s34, 10
  v_add_u32 v23, s34, v22
  s_mov_b32 s36, L2_text_end-gather_scatter__tensor_product_equiv_tfn__graph_kernel-15
  v_cmp_gt_u32 vcc, s36, v23
  s_and_saveexec_b64 s[36:37], vcc
  s_cbranch_execz L1_code_done
  global_load_dwordx4 v[52:55], v23, s[62:63]
L1_code_done:
  s_mov_b64 exec, s[36:37]
L1_nocode:
  s_mov_b32 s35, 109951163
  v_mov_b32 v17, 1
  s_barrier
  s_waitcnt vmcnt(2)
  v_mul_hi_u32 v12, s35, v6
  v_min_u32 v12, 255, v12
  v_and_b32 v14, 7, v12
  v_lshlrev_b32 v14, 7, v14
  v_lshrrev_b32 v16, 3, v12
  v_lshl_add_u32 v14, v16, 2, v14
  ds_add_rtn_u32 v18, v14, v17 offset:0
  v_mul_u32_u24 v26, 625, v12
  v_add_u32 v26, 15, v26
  v_lshrrev_b32 v26, 4, v26
  v_sub_u32 v26, v6, v26
  v_mul_hi_u32 v13, s35, v7
  v_min_u32 v13, 255, v13
  v_and_b32 v15, 7, v13
  v_lshlrev_b32 v15, 7, v15
  v_lshrrev_b32 v16, 3, v13
  v_lshl_add_u32 v15, v16, 2, v15
  ds_add_rtn_u32 v19, v15, v17 offset:0
  v_mul_u32_u24 v27, 625, v13
  v_add_u32 v27, 15, v27
  v_lshrrev_b32 v27, 4, v27
  v_sub_u32 v27, v7, v27
  s_waitcnt vmcnt(1)
  v_lshl_or_b32 v8, v24, 10, v26
  v_lshlrev_b32 v9, 5, v3
  v_lshl_or_b32 v32, v25, 10, v27
  v_add_u32 v33, 32, v9
  s_waitcnt lgkmcnt(0)
  s_barrier
  s_cmp_lg_u32 s15, 0
  s_cbranch_scc1 L1_noscan
  ds_read_b128 v[36:39], v22 offset:0
  s_waitcnt lgkmcnt(0)
  v_add_u32 v40, v36, v37
  v_add_u32 v41, v40, v38
  v_add_u32 v42, v41, v39
  v_mov_b32 v43, v42
  s_nop 1
  v_add_u32_dpp v43, v43, v43 row_shr:1 row_mask:0xf bank_mask:0xf bound_ctrl:0
  s_nop 1
  v_add_u32_dpp v43, v43, v43 row_shr:2 row_mask:0xf bank_mask:0xf bound_ctrl:0
  s_nop 1
  v_add_u32_dpp v43, v43, v43 row_shr:4 row_mask:0xf bank_mask:0xf bound_ctrl:0
  s_nop 1
  v_add_u32_dpp v43, v43, v43 row_shr:8 row_mask:0xf bank_mask:0xf bound_ctrl:0
  s_nop 1
  v_add_u32_dpp v43, v43, v43 row_bcast:15 row_mask:0xa bank_mask:0xf
  s_nop 1
  v_add_u32_dpp v43, v43, v43 row_bcast:31 row_mask:0xc bank_mask:0xf
  v_sub_u32 v44, v43, v42
  v_add_u32 v45, v44, v36
  v_add_u32 v46, v44, v40
  v_add_u32 v47, v44, v41
  ds_write_b128 v22, v[44:47] offset:1024
  v_lshl_or_b32 v36, v36, 16, v44
  v_lshl_or_b32 v37, v37, 16, v45
  v_lshl_or_b32 v38, v38, 16, v46
  v_lshl_or_b32 v39, v39, 16, v47
  s_lshl_b32 s12, s2, 10
  buffer_store_dwordx4 v[36:39], v22, s[28:31], s12 offen offset:0 sc1
  s_waitcnt lgkmcnt(0)
L1_noscan:
  s_barrier
  ds_read_b32 v12, v14 offset:1024
  ds_read_b32 v13, v15 offset:1024
  s_cmp_lg_u32 s15, 0
  s_cbranch_scc1 L1_w1
  s_waitcnt vmcnt(1)
  s_branch L1_w2
L1_w1:
  s_waitcnt vmcnt(0)
L1_w2:
  v_mov_b32 v10, v28
  v_mov_b32 v11, v29
  v_mov_b32 v34, v30
  v_mov_b32 v35, v31
  s_waitcnt lgkmcnt(0)
  v_add_u32 v12, v12, v18
  v_add_u32 v13, v13, v19
  v_lshlrev_b32 v12, 4, v12
  v_lshlrev_b32 v13, 4, v13
  ds_write_b128 v12, v[8:11] offset:2048
  ds_write_b128 v13, v[32:35] offset:2048
  s_waitcnt lgkmcnt(0)
  s_barrier
  v_lshlrev_b32 v20, 4, v0
  ds_read_b128 v[8:11], v20 offset:2048
  ds_read_b128 v[32:35], v20 offset:7168
  s_lshl_b32 s12, s14, 4
  s_add_u32 s12, s12, 262144
  s_add_u32 s13, s12, 5120
  s_waitcnt lgkmcnt(1)
  buffer_store_dwordx4 v[8:11], v20, s[28:31], s12 offen sc1
  s_waitcnt lgkmcnt(0)
  buffer_store_dwordx4 v[32:35], v20, s[28:31], s13 offen sc1
L1_end:
  s_endpgm
.globl gather_scatter__tensor_product_equiv_tfn__graph_kernel
.p2align 8
.type gather_scatter__tensor_product_equiv_tfn__graph_kernel,@function
gather_scatter__tensor_product_equiv_tfn__graph_kernel:
  s_cmp_ge_u32 s2, 256
  s_cbranch_scc1 L2_end
  s_load_dwordx2 s[6:7], s[0:1], 80
  s_load_dwordx2 s[4:5], s[0:1], 0
  s_load_dwordx4 s[84:87], s[0:1], 40
  s_load_dwordx4 s[40:43], s[0:1], 56
  s_load_dwordx2 s[44:45], s[0:1], 32
  v_and_b32 v1, 63, v0
  v_lshrrev_b32 v3, 6, v0
  v_lshlrev_b32 v2, 4, v1
  v_readfirstlane_b32 s28, v3
  v_lshlrev_b32 v4, 2, v0
  v_mov_b32 v5, 0
  ds_write_b32 v4, v5 offset:0
  v_cmp_gt_u32 vcc, 16, v0
  s_and_saveexec_b64 s[76:77], vcc
  ds_write_b32 v4, v5 offset:2048
  s_mov_b64 exec, s[76:77]
  v_cmp_gt_u32 vcc, 64, v0
  s_and_saveexec_b64 s[76:77], vcc
  ds_write_b32 v4, v0 offset:2176
  ds_write_b32 v4, v5 offset:2432
  s_mov_b64 exec, s[76:77]
  v_lshrrev_b32 v3, 1, v0
  v_and_b32 v9, 1, v0
  s_and_b32 s35, s2, 7
  s_lshl_b32 s35, s35, 5
  s_lshr_b32 s36, s2, 3
  s_add_u32 s35, s35, s36
  s_lshl_b32 s35, s35, 2
  v_lshlrev_b32 v6, 10, v3
  v_mul_u32_u24 v8, 640, v3
  s_mul_i32 s17, s28, 4608
  s_add_u32 s17, s17, 6144
  s_mul_i32 s16, s28, 9216
  s_add_u32 s16, s16, 75776
  s_waitcnt lgkmcnt(0)
  s_mov_b32 s80, s6
  s_mov_b32 s81, s7
  s_mov_b32 s82, 256000
  s_mov_b32 s83, 0x20000
  buffer_load_dword v240, v6, s[80:83], s35 offen sc0 sc1 nt
  s_mov_b32 s24, s84
  s_mov_b32 s25, s85
  s_mov_b32 s26, 4096
  s_mov_b32 s27, 0x20000
  s_lshl_b32 s36, s28, 10
  s_add_u32 m0, s36, 149504
  s_cmp_ge_u32 s28, 4
  s_cbranch_scc0 L2_aux_go
  s_mov_b32 s24, s86
  s_mov_b32 s25, s87
  s_mov_b32 s26, 128
  s_mov_b32 s27, 0x20000
  s_mov_b32 s36, 0
  s_mov_b32 m0, 153600
  s_mov_b64 exec, 0xff
  s_cmp_eq_u32 s28, 4
  s_cbranch_scc1 L2_aux_go
  s_movk_i32 s36, 0x1000
  s_mov_b32 m0, 153728
L2_aux_go:
  s_nop 0
  buffer_load_dwordx4 v2, s[24:27], s36 offen lds
  s_mov_b64 exec, -1
  s_mov_b32 s24, s40
  s_mov_b32 s25, s41
  s_mov_b32 s26, 32768
  s_mov_b32 s27, 0x20000
  v_lshlrev_b32 v242, 4, v0
  s_movk_i32 s36, 0
  buffer_load_dwordx4 v[108:111], v242, s[24:27], s36 offen
  s_movk_i32 s36, 8192
  buffer_load_dwordx4 v[112:115], v242, s[24:27], s36 offen
  s_movk_i32 s36, 16384
  buffer_load_dwordx4 v[116:119], v242, s[24:27], s36 offen
  s_movk_i32 s36, 24576
  buffer_load_dwordx4 v[120:123], v242, s[24:27], s36 offen
  s_mov_b32 s8, s4
  s_mov_b32 s9, s5
  s_mov_b32 s10, 10240000
  s_mov_b32 s11, 0x20000
  s_mov_b32 s12, s6
  s_mov_b32 s13, s7
  s_mov_b32 s14, 7942144
  s_mov_b32 s15, 0x20000
  s_mov_b32 s20, s42
  s_mov_b32 s21, s43
  s_mov_b32 s22, 10240000
  s_mov_b32 s23, 0x20000
  s_mov_b32 s4, s44
  s_mov_b32 s5, s45
  s_mov_b32 s6, 5120000
  s_mov_b32 s7, 0x20000
  s_mov_b32 s31, 0
  s_mov_b32 s32, 16
  v_mov_b32 v185, -1
  v_mov_b32 v189, -1
  v_mov_b32 v193, -1
  v_mov_b32 v197, -1
  v_mov_b32 v201, -1
  v_mov_b32 v205, -1
  v_mov_b32 v209, -1
  v_mov_b32 v213, -1
  v_mov_b32 v136, 0
  v_mov_b32 v137, 0
  v_mov_b32 v138, 0
  v_mov_b32 v139, 0
  v_mov_b32 v140, 0
  v_mov_b32 v141, 0
  v_mov_b32 v142, 0
  v_mov_b32 v143, 0
  v_mov_b32 v144, 0
  v_mov_b32 v145, 0
  v_mov_b32 v146, 0
  v_mov_b32 v147, 0
  v_mov_b32 v148, 0
  v_mov_b32 v149, 0
  v_mov_b32 v150, 0
  v_mov_b32 v151, 0
  v_mov_b32 v152, 0
  v_mov_b32 v153, 0
  v_mov_b32 v154, 0
  v_mov_b32 v155, 0
  v_mov_b32 v156, 0
  v_mov_b32 v157, 0
  v_mov_b32 v158, 0
  v_mov_b32 v159, 0
  v_mov_b32 v160, 0
  v_mov_b32 v161, 0
  v_mov_b32 v162, 0
  v_mov_b32 v163, 0
  v_mov_b32 v164, 0
  v_mov_b32 v165, 0
  v_mov_b32 v166, 0
  v_mov_b32 v167, 0
  v_mov_b32 v168, 0
  v_mov_b32 v169, 0
  v_mov_b32 v170, 0
  v_mov_b32 v171, 0
  v_mov_b32 v172, 0
  v_mov_b32 v173, 0
  v_mov_b32 v174, 0
  v_mov_b32 v175, 0
  v_mov_b32 v176, 0
  v_mov_b32 v177, 0
  v_mov_b32 v178, 0
  v_mov_b32 v179, 0
  v_mov_b32 v180, 0
  v_mov_b32 v181, 0
  v_mov_b32 v182, 0
  v_mov_b32 v183, 0
  s_mov_b32 s38, 0xbfb8aa3b
  s_mov_b32 s39, 0xbfb8aa3b
  s_mov_b32 s78, 0x05040100
  s_mov_b32 s79, 0x07060302
  s_barrier
  s_waitcnt vmcnt(5)
  v_lshrrev_b32 v7, 16, v240
  v_and_b32 v240, 0xffff, v240
  v_add3_u32 v8, v8, v240, v9
  v_lshlrev_b32 v8, 4, v8
  s_add_u32 s35, s31, s32
  v_min_u32 v241, s35, v7
  v_subrev_u32 v241, s31, v241
  v_sub_u32 v241, v241, v9
  s_lshl_b32 s35, s31, 4
  s_add_u32 s35, s35, 262144
  v_cmp_lt_i32 s[40:41], 0, v241
  v_cmp_lt_i32 s[42:43], 2, v241
  v_cmp_lt_i32 s[44:45], 4, v241
  v_cmp_lt_i32 s[46:47], 6, v241
  v_cmp_lt_i32 s[48:49], 8, v241
  v_cmp_lt_i32 s[50:51], 10, v241
  v_cmp_lt_i32 s[52:53], 12, v241
  v_cmp_lt_i32 s[54:55], 14, v241
  s_nop 3
  s_cmp_eq_u64 s[40:41], 0
  s_cbranch_scc1 L2_first_done
  s_mov_b64 exec, s[40:41]
  buffer_load_dwordx4 v[184:187], v8, s[12:15], s35 offen offset:0 sc0 sc1 nt
  s_cmp_eq_u64 s[42:43], 0
  s_cbranch_scc1 L2_first_done
  s_mov_b64 exec, s[42:43]
  buffer_load_dwordx4 v[188:191], v8, s[12:15], s35 offen offset:32 sc0 sc1 nt
  s_cmp_eq_u64 s[44:45], 0
  s_cbranch_scc1 L2_first_done
  s_mov_b64 exec, s[44:45]
  buffer_load_dwordx4 v[192:195], v8, s[12:15], s35 offen offset:64 sc0 sc1 nt
  s_cmp_eq_u64 s[46:47], 0
  s_cbranch_scc1 L2_first_done
  s_mov_b64 exec, s[46:47]
  buffer_load_dwordx4 v[196:199], v8, s[12:15], s35 offen offset:96 sc0 sc1 nt
  s_cmp_eq_u64 s[48:49], 0
  s_cbranch_scc1 L2_first_done
  s_mov_b64 exec, s[48:49]
  buffer_load_dwordx4 v[200:203], v8, s[12:15], s35 offen offset:128 sc0 sc1 nt
  s_cmp_eq_u64 s[50:51], 0
  s_cbranch_scc1 L2_first_done
  s_mov_b64 exec, s[50:51]
  buffer_load_dwordx4 v[204:207], v8, s[12:15], s35 offen offset:160 sc0 sc1 nt
  s_cmp_eq_u64 s[52:53], 0
  s_cbranch_scc1 L2_first_done
  s_mov_b64 exec, s[52:53]
  buffer_load_dwordx4 v[208:211], v8, s[12:15], s35 offen offset:192 sc0 sc1 nt
  s_cmp_eq_u64 s[54:55], 0
  s_cbranch_scc1 L2_first_done
  s_mov_b64 exec, s[54:55]
  buffer_load_dwordx4 v[212:215], v8, s[12:15], s35 offen offset:224 sc0 sc1 nt
L2_first_done:
  s_mov_b64 exec, -1
L2_stage:
  v_cmp_lt_u32 vcc, 16, v7
  s_and_saveexec_b64 s[76:77], vcc
  s_cbranch_execz L2_nomax
  v_mov_b32 v4, 2052
  ds_max_u32 v4, v7
L2_nomax:
  s_mov_b64 exec, s[76:77]
  s_waitcnt vmcnt(0)
  s_cmp_eq_u64 s[40:41], 0
  s_cbranch_scc1 L2_touch_done1
  s_mov_b64 exec, s[40:41]
  buffer_load_dword v104, v185, s[4:7], 0 offen
  s_cmp_eq_u64 s[42:43], 0
  s_cbranch_scc1 L2_touch_done1
  s_mov_b64 exec, s[42:43]
  buffer_load_dword v104, v189, s[4:7], 0 offen
  s_cmp_eq_u64 s[44:45], 0
  s_cbranch_scc1 L2_touch_done1
  s_mov_b64 exec, s[44:45]
  buffer_load_dword v104, v193, s[4:7], 0 offen
  s_cmp_eq_u64 s[46:47], 0
  s_cbranch_scc1 L2_touch_done1
  s_mov_b64 exec, s[46:47]
  buffer_load_dword v104, v197, s[4:7], 0 offen
  s_cmp_eq_u64 s[48:49], 0
  s_cbranch_scc1 L2_touch_done1
  s_mov_b64 exec, s[48:49]
  buffer_load_dword v104, v201, s[4:7], 0 offen
  s_cmp_eq_u64 s[50:51], 0
  s_cbranch_scc1 L2_touch_done1
  s_mov_b64 exec, s[50:51]
  buffer_load_dword v104, v205, s[4:7], 0 offen
  s_cmp_eq_u64 s[52:53], 0
  s_cbranch_scc1 L2_touch_done1
  s_mov_b64 exec, s[52:53]
  buffer_load_dword v104, v209, s[4:7], 0 offen
  s_cmp_eq_u64 s[54:55], 0
  s_cbranch_scc1 L2_touch_done1
  s_mov_b64 exec, s[54:55]
  buffer_load_dword v104, v213, s[4:7], 0 offen
L2_touch_done1:
  s_mov_b64 exec, -1
  v_mov_b32 v6, 64
  s_cmp_eq_u64 s[40:41], 0
  s_cbranch_scc1 L2_deg_done
  s_mov_b64 exec, s[40:41]
  v_and_b32 v3, 63, v184
  v_lshlrev_b32 v3, 2, v3
  ds_add_u32 v3, v6 offset:2176
  s_cmp_eq_u64 s[42:43], 0
  s_cbranch_scc1 L2_deg_done
  s_mov_b64 exec, s[42:43]
  v_and_b32 v3, 63, v188
  v_lshlrev_b32 v3, 2, v3
  ds_add_u32 v3, v6 offset:2176
  s_cmp_eq_u64 s[44:45], 0
  s_cbranch_scc1 L2_deg_done
  s_mov_b64 exec, s[44:45]
  v_and_b32 v3, 63, v192
  v_lshlrev_b32 v3, 2, v3
  ds_add_u32 v3, v6 offset:2176
  s_cmp_eq_u64 s[46:47], 0
  s_cbranch_scc1 L2_deg_done
  s_mov_b64 exec, s[46:47]
  v_and_b32 v3, 63, v196
  v_lshlrev_b32 v3, 2, v3
  ds_add_u32 v3, v6 offset:2176
  s_cmp_eq_u64 s[48:49], 0
  s_cbranch_scc1 L2_deg_done
  s_mov_b64 exec, s[48:49]
  v_and_b32 v3, 63, v200
  v_lshlrev_b32 v3, 2, v3
  ds_add_u32 v3, v6 offset:2176
  s_cmp_eq_u64 s[50:51], 0
  s_cbranch_scc1 L2_deg_done
  s_mov_b64 exec, s[50:51]
  v_and_b32 v3, 63, v204
  v_lshlrev_b32 v3, 2, v3
  ds_add_u32 v3, v6 offset:2176
  s_cmp_eq_u64 s[52:53], 0
  s_cbranch_scc1 L2_deg_done
  s_mov_b64 exec, s[52:53]
  v_and_b32 v3, 63, v208
  v_lshlrev_b32 v3, 2, v3
  ds_add_u32 v3, v6 offset:2176
  s_cmp_eq_u64 s[54:55], 0
  s_cbranch_scc1 L2_deg_done
  s_mov_b64 exec, s[54:55]
  v_and_b32 v3, 63, v212
  v_lshlrev_b32 v3, 2, v3
  ds_add_u32 v3, v6 offset:2176
L2_deg_done:
  s_mov_b64 exec, -1
  v_lshrrev_b32 v3, 4, v0
  v_and_b32 v4, 7, v3
  v_lshlrev_b32 v4, 1, v4
  v_bfe_u32 v5, v0, 2, 2
  v_lshlrev_b32 v5, 2, v5
  v_bfe_u32 v243, v0, 1, 1
  v_add_u32 v5, v5, v243
  v_xor_b32 v5, v5, v4
  v_lshlrev_b32 v5, 4, v5
  v_and_b32 v243, 1, v0
  v_lshl_add_u32 v5, v243, 3, v5
  v_lshl_add_u32 v5, v3, 8, v5
  v_add_u32 v5, 43008, v5
  v_xor_b32 v4, 32, v5
  v_perm_b32 v88, v109, v108, s78
  v_perm_b32 v89, v111, v110, s78
  v_perm_b32 v90, v109, v108, s79
  v_perm_b32 v91, v111, v110, s79
  ds_write_b64 v5, v[88:89] offset:0
  ds_write_b64 v4, v[90:91] offset:0
  v_perm_b32 v92, v113, v112, s78
  v_perm_b32 v93, v115, v114, s78
  v_perm_b32 v94, v113, v112, s79
  v_perm_b32 v95, v115, v114, s79
  ds_write_b64 v5, v[92:93] offset:8192
  ds_write_b64 v4, v[94:95] offset:8192
  v_perm_b32 v88, v117, v116, s78
  v_perm_b32 v89, v119, v118, s78
  v_perm_b32 v90, v117, v116, s79
  v_perm_b32 v91, v119, v118, s79
  ds_write_b64 v5, v[88:89] offset:16384
  ds_write_b64 v4, v[90:91] offset:16384
  v_perm_b32 v92, v121, v120, s78
  v_perm_b32 v93, v123, v122, s78
  v_perm_b32 v94, v121, v120, s79
  v_perm_b32 v95, v123, v122, s79
  ds_write_b64 v5, v[92:93] offset:24576
  ds_write_b64 v4, v[94:95] offset:24576
  s_waitcnt lgkmcnt(0)
  s_barrier
  v_lshlrev_b32 v3, 2, v1
  s_mul_i32 s35, s28, 20
  v_mov_b32 v4, s35
  ds_read_b32 v5, v3 offset:2176
  ds_read_b32 v216, v4 offset:2176
  ds_read_b32 v217, v4 offset:2180
  ds_read_b32 v218, v4 offset:2184
  ds_read_b32 v219, v4 offset:2188
  ds_read_b32 v220, v4 offset:2192
  v_mov_b32 v6, 0
  s_waitcnt lgkmcnt(0)
  v_cmp_gt_u32 s[56:57], v216, v5
  v_cmp_gt_u32 s[58:59], v217, v5
  v_cmp_gt_u32 s[60:61], v218, v5
  v_cmp_gt_u32 s[62:63], v219, v5
  v_cmp_gt_u32 s[64:65], v220, v5
  s_nop 1
  v_addc_co_u32 v6, vcc, 0, v6, s[56:57]
  v_addc_co_u32 v6, vcc, 0, v6, s[58:59]
  v_addc_co_u32 v6, vcc, 0, v6, s[60:61]
  v_addc_co_u32 v6, vcc, 0, v6, s[62:63]
  v_addc_co_u32 v6, vcc, 0, v6, s[64:65]
  ds_add_u32 v3, v6 offset:2432
  s_waitcnt lgkmcnt(0)
  s_barrier
  ds_read_b32 v5, v3 offset:2432
  v_mov_b32 v4, 0
  v_mov_b32 v6, 0
  s_waitcnt lgkmcnt(0)
  v_cmp_le_u32 vcc, 12, v5
  v_mov_b32 v242, 12
  v_mov_b32 v243, 4
  v_cndmask_b32 v4, v4, v242, vcc
  v_cndmask_b32 v6, v6, v243, vcc
  v_cmp_le_u32 vcc, 24, v5
  v_mov_b32 v242, 12
  v_mov_b32 v243, 0
  v_cndmask_b32 v4, v4, v242, vcc
  v_cndmask_b32 v6, v6, v243, vcc
  v_cmp_le_u32 vcc, 32, v5
  v_mov_b32 v242, 20
  v_mov_b32 v243, 4
  v_cndmask_b32 v4, v4, v242, vcc
  v_cndmask_b32 v6, v6, v243, vcc
  v_sub_u32 v5, v5, v4
  v_bfe_i32 v4, v5, 2, 1
  v_xor_b32 v4, v4, v5
  v_and_b32 v4, 3, v4
  v_or_b32 v4, v4, v6
  v_lshrrev_b32 v5, 2, v5
  v_min_u32 v5, 5, v5
  v_lshlrev_b32 v6, 8, v4
  v_lshl_or_b32 v6, v5, 3, v6
  s_lshl_b32 s35, s28, 8
  v_add_u32 v242, s35, v3
  ds_write_b32 v242, v6 offset:4096
  s_cmp_lg_u32 s28, 0
  s_cbranch_scc1 L2_map_done
  v_cmp_gt_u32 vcc, 40, v1
  s_and_saveexec_b64 s[76:77], vcc
  v_mul_u32_u24 v4, 5, v4
  v_add_u32 v4, v4, v5
  v_lshlrev_b32 v4, 2, v4
  ds_write_b32 v4, v1 offset:2688
  s_mov_b64 exec, s[76:77]
L2_map_done:
  s_waitcnt lgkmcnt(0)
  s_branch L2_pass_keys
L2_pass:
  s_add_u32 s35, s31, s32
  v_min_u32 v241, s35, v7
  v_subrev_u32 v241, s31, v241
  v_sub_u32 v241, v241, v9
  s_lshl_b32 s35, s31, 4
  s_add_u32 s35, s35, 262144
  v_cmp_lt_i32 s[40:41], 0, v241
  v_cmp_lt_i32 s[42:43], 2, v241
  v_cmp_lt_i32 s[44:45], 4, v241
  v_cmp_lt_i32 s[46:47], 6, v241
  v_cmp_lt_i32 s[48:49], 8, v241
  v_cmp_lt_i32 s[50:51], 10, v241
  v_cmp_lt_i32 s[52:53], 12, v241
  v_cmp_lt_i32 s[54:55], 14, v241
  s_nop 3
  s_cmp_eq_u64 s[40:41], 0
  s_cbranch_scc1 L2_ld_done
  s_mov_b64 exec, s[40:41]
  buffer_load_dwordx4 v[184:187], v8, s[12:15], s35 offen offset:0 sc0 sc1 nt
  s_cmp_eq_u64 s[42:43], 0
  s_cbranch_scc1 L2_ld_done
  s_mov_b64 exec, s[42:43]
  buffer_load_dwordx4 v[188:191], v8, s[12:15], s35 offen offset:32 sc0 sc1 nt
  s_cmp_eq_u64 s[44:45], 0
  s_cbranch_scc1 L2_ld_done
  s_mov_b64 exec, s[44:45]
  buffer_load_dwordx4 v[192:195], v8, s[12:15], s35 offen offset:64 sc0 sc1 nt
  s_cmp_eq_u64 s[46:47], 0
  s_cbranch_scc1 L2_ld_done
  s_mov_b64 exec, s[46:47]
  buffer_load_dwordx4 v[196:199], v8, s[12:15], s35 offen offset:96 sc0 sc1 nt
  s_cmp_eq_u64 s[48:49], 0
  s_cbranch_scc1 L2_ld_done
  s_mov_b64 exec, s[48:49]
  buffer_load_dwordx4 v[200:203], v8, s[12:15], s35 offen offset:128 sc0 sc1 nt
  s_cmp_eq_u64 s[50:51], 0
  s_cbranch_scc1 L2_ld_done
  s_mov_b64 exec, s[50:51]
  buffer_load_dwordx4 v[204:207], v8, s[12:15], s35 offen offset:160 sc0 sc1 nt
  s_cmp_eq_u64 s[52:53], 0
  s_cbranch_scc1 L2_ld_done
  s_mov_b64 exec, s[52:53]
  buffer_load_dwordx4 v[208:211], v8, s[12:15], s35 offen offset:192 sc0 sc1 nt
  s_cmp_eq_u64 s[54:55], 0
  s_cbranch_scc1 L2_ld_done
  s_mov_b64 exec, s[54:55]
  buffer_load_dwordx4 v[212:215], v8, s[12:15], s35 offen offset:224 sc0 sc1 nt
L2_ld_done:
  s_mov_b64 exec, -1
  s_waitcnt vmcnt(0)
L2_pass_keys:
  s_lshl_b32 s35, s28, 8
  s_cmp_eq_u64 s[40:41], 0
  s_cbranch_scc1 L2_rk_done
  s_mov_b64 exec, s[40:41]
  v_and_b32 v3, 63, v184
  v_lshl_add_u32 v3, v3, 2, s35
  ds_read_b32 v232, v3 offset:4096
  s_cmp_eq_u64 s[42:43], 0
  s_cbranch_scc1 L2_rk_done
  s_mov_b64 exec, s[42:43]
  v_and_b32 v3, 63, v188
  v_lshl_add_u32 v3, v3, 2, s35
  ds_read_b32 v233, v3 offset:4096
  s_cmp_eq_u64 s[44:45], 0
  s_cbranch_scc1 L2_rk_done
  s_mov_b64 exec, s[44:45]
  v_and_b32 v3, 63, v192
  v_lshl_add_u32 v3, v3, 2, s35
  ds_read_b32 v234, v3 offset:4096
  s_cmp_eq_u64 s[46:47], 0
  s_cbranch_scc1 L2_rk_done
  s_mov_b64 exec, s[46:47]
  v_and_b32 v3, 63, v196
  v_lshl_add_u32 v3, v3, 2, s35
  ds_read_b32 v235, v3 offset:4096
  s_cmp_eq_u64 s[48:49], 0
  s_cbranch_scc1 L2_rk_done
  s_mov_b64 exec, s[48:49]
  v_and_b32 v3, 63, v200
  v_lshl_add_u32 v3, v3, 2, s35
  ds_read_b32 v236, v3 offset:4096
  s_cmp_eq_u64 s[50:51], 0
  s_cbranch_scc1 L2_rk_done
  s_mov_b64 exec, s[50:51]
  v_and_b32 v3, 63, v204
  v_lshl_add_u32 v3, v3, 2, s35
  ds_read_b32 v237, v3 offset:4096
  s_cmp_eq_u64 s[52:53], 0
  s_cbranch_scc1 L2_rk_done
  s_mov_b64 exec, s[52:53]
  v_and_b32 v3, 63, v208
  v_lshl_add_u32 v3, v3, 2, s35
  ds_read_b32 v238, v3 offset:4096
  s_cmp_eq_u64 s[54:55], 0
  s_cbranch_scc1 L2_rk_done
  s_mov_b64 exec, s[54:55]
  v_and_b32 v3, 63, v212
  v_lshl_add_u32 v3, v3, 2, s35
  ds_read_b32 v239, v3 offset:4096
L2_rk_done:
  s_mov_b64 exec, -1
  v_mov_b32 v6, 1
  s_waitcnt lgkmcnt(0)
  s_cmp_eq_u64 s[40:41], 0
  s_cbranch_scc1 L2_key_done
  s_mov_b64 exec, s[40:41]
  v_lshrrev_b32 v4, 18, v184
  v_min_u32 v4, 63, v4
  v_lshlrev_b32 v4, 2, v4
  v_and_b32 v3, 0x700, v232
  v_add_u32 v216, v3, v4
  ds_add_rtn_u32 v224, v216, v6 offset:0
  v_and_b32 v184, 0xffffffc0, v184
  v_and_or_b32 v184, v232, 56, v184
  s_cmp_eq_u64 s[42:43], 0
  s_cbranch_scc1 L2_key_done
  s_mov_b64 exec, s[42:43]
  v_lshrrev_b32 v4, 18, v188
  v_min_u32 v4, 63, v4
  v_lshlrev_b32 v4, 2, v4
  v_and_b32 v3, 0x700, v233
  v_add_u32 v217, v3, v4
  ds_add_rtn_u32 v225, v217, v6 offset:0
  v_and_b32 v188, 0xffffffc0, v188
  v_and_or_b32 v188, v233, 56, v188
  s_cmp_eq_u64 s[44:45], 0
  s_cbranch_scc1 L2_key_done
  s_mov_b64 exec, s[44:45]
  v_lshrrev_b32 v4, 18, v192
  v_min_u32 v4, 63, v4
  v_lshlrev_b32 v4, 2, v4
  v_and_b32 v3, 0x700, v234
  v_add_u32 v218, v3, v4
  ds_add_rtn_u32 v226, v218, v6 offset:0
  v_and_b32 v192, 0xffffffc0, v192
  v_and_or_b32 v192, v234, 56, v192
  s_cmp_eq_u64 s[46:47], 0
  s_cbranch_scc1 L2_key_done
  s_mov_b64 exec, s[46:47]
  v_lshrrev_b32 v4, 18, v196
  v_min_u32 v4, 63, v4
  v_lshlrev_b32 v4, 2, v4
  v_and_b32 v3, 0x700, v235
  v_add_u32 v219, v3, v4
  ds_add_rtn_u32 v227, v219, v6 offset:0
  v_and_b32 v196, 0xffffffc0, v196
  v_and_or_b32 v196, v235, 56, v196
  s_cmp_eq_u64 s[48:49], 0
  s_cbranch_scc1 L2_key_done
  s_mov_b64 exec, s[48:49]
  v_lshrrev_b32 v4, 18, v200
  v_min_u32 v4, 63, v4
  v_lshlrev_b32 v4, 2, v4
  v_and_b32 v3, 0x700, v236
  v_add_u32 v220, v3, v4
  ds_add_rtn_u32 v228, v220, v6 offset:0
  v_and_b32 v200, 0xffffffc0, v200
  v_and_or_b32 v200, v236, 56, v200
  s_cmp_eq_u64 s[50:51], 0
  s_cbranch_scc1 L2_key_done
  s_mov_b64 exec, s[50:51]
  v_lshrrev_b32 v4, 18, v204
  v_min_u32 v4, 63, v4
  v_lshlrev_b32 v4, 2, v4
  v_and_b32 v3, 0x700, v237
  v_add_u32 v221, v3, v4
  ds_add_rtn_u32 v229, v221, v6 offset:0
  v_and_b32 v204, 0xffffffc0, v204
  v_and_or_b32 v204, v237, 56, v204
  s_cmp_eq_u64 s[52:53], 0
  s_cbranch_scc1 L2_key_done
  s_mov_b64 exec, s[52:53]
  v_lshrrev_b32 v4, 18, v208
  v_min_u32 v4, 63, v4
  v_lshlrev_b32 v4, 2, v4
  v_and_b32 v3, 0x700, v238
  v_add_u32 v222, v3, v4
  ds_add_rtn_u32 v230, v222, v6 offset:0
  v_and_b32 v208, 0xffffffc0, v208
  v_and_or_b32 v208, v238, 56, v208
  s_cmp_eq_u64 s[54:55], 0
  s_cbranch_scc1 L2_key_done
  s_mov_b64 exec, s[54:55]
  v_lshrrev_b32 v4, 18, v212
  v_min_u32 v4, 63, v4
  v_lshlrev_b32 v4, 2, v4
  v_and_b32 v3, 0x700, v239
  v_add_u32 v223, v3, v4
  ds_add_rtn_u32 v231, v223, v6 offset:0
  v_and_b32 v212, 0xffffffc0, v212
  v_and_or_b32 v212, v239, 56, v212
L2_key_done:
  s_mov_b64 exec, -1
  s_waitcnt lgkmcnt(0)
  s_barrier
  s_lshl_b32 s35, s28, 8
  v_lshl_add_u32 v3, v1, 2, s35
  ds_read_b32 v4, v3 offset:0
  s_waitcnt lgkmcnt(0)
  v_mov_b32 v5, v4
  s_nop 1
  v_add_u32_dpp v5, v5, v5 row_shr:1 row_mask:0xf bank_mask:0xf bound_ctrl:0
  s_nop 1
  v_add_u32_dpp v5, v5, v5 row_shr:2 row_mask:0xf bank_mask:0xf bound_ctrl:0
  s_nop 1
  v_add_u32_dpp v5, v5, v5 row_shr:4 row_mask:0xf bank_mask:0xf bound_ctrl:0
  s_nop 1
  v_add_u32_dpp v5, v5, v5 row_shr:8 row_mask:0xf bank_mask:0xf bound_ctrl:0
  s_nop 1
  v_add_u32_dpp v5, v5, v5 row_bcast:15 row_mask:0xa bank_mask:0xf
  s_nop 1
  v_add_u32_dpp v5, v5, v5 row_bcast:31 row_mask:0xc bank_mask:0xf
  v_sub_u32 v4, v5, v4
  v_readlane_b32 s29, v5, 63
  ds_write_b32 v3, v4 offset:0
  s_cmp_gt_u32 s29, 256
  s_cbranch_scc0 L2_noovf
  v_mov_b32 v3, 2048
  v_mov_b32 v4, 1
  ds_write_b32 v3, v4
  s_branch L2_padded
L2_noovf:
  s_lshl_b32 s35, s29, 4
  s_add_u32 s35, s35, s17
  v_add_u32 v3, s35, v2
  v_mov_b32 v16, 2147482664
  v_mov_b32 v17, 2147483616
  v_mov_b32 v18, 0
  v_mov_b32 v19, 0
  s_mov_b32 exec_hi, 0
  ds_write_b128 v3, v[16:19]
  s_mov_b64 exec, -1
L2_padded:
  s_waitcnt lgkmcnt(0)
  s_barrier
  v_mov_b32 v3, 2048
  ds_read_b64 v[22:23], v3
  s_cmp_eq_u64 s[40:41], 0
  s_cbranch_scc1 L2_base_done
  s_mov_b64 exec, s[40:41]
  ds_read_b32 v232, v216 offset:0
  s_cmp_eq_u64 s[42:43], 0
  s_cbranch_scc1 L2_base_done
  s_mov_b64 exec, s[42:43]
  ds_read_b32 v233, v217 offset:0
  s_cmp_eq_u64 s[44:45], 0
  s_cbranch_scc1 L2_base_done
  s_mov_b64 exec, s[44:45]
  ds_read_b32 v234, v218 offset:0
  s_cmp_eq_u64 s[46:47], 0
  s_cbranch_scc1 L2_base_done
  s_mov_b64 exec, s[46:47]
  ds_read_b32 v235, v219 offset:0
  s_cmp_eq_u64 s[48:49], 0
  s_cbranch_scc1 L2_base_done
  s_mov_b64 exec, s[48:49]
  ds_read_b32 v236, v220 offset:0
  s_cmp_eq_u64 s[50:51], 0
  s_cbranch_scc1 L2_base_done
  s_mov_b64 exec, s[50:51]
  ds_read_b32 v237, v221 offset:0
  s_cmp_eq_u64 s[52:53], 0
  s_cbranch_scc1 L2_base_done
  s_mov_b64 exec, s[52:53]
  ds_read_b32 v238, v222 offset:0
  s_cmp_eq_u64 s[54:55], 0
  s_cbranch_scc1 L2_base_done
  s_mov_b64 exec, s[54:55]
  ds_read_b32 v239, v223 offset:0
L2_base_done:
  s_mov_b64 exec, -1
  s_waitcnt lgkmcnt(0)
  v_readfirstlane_b32 s37, v22
  v_readfirstlane_b32 s33, v23
  s_cmp_lg_u32 s37, 0
  s_cbranch_scc1 L2_overflow
  s_cmp_eq_u64 s[40:41], 0
  s_cbranch_scc1 L2_scat_done
  s_mov_b64 exec, s[40:41]
  v_lshrrev_b32 v3, 8, v216
  v_mul_u32_u24 v3, 4608, v3
  v_add_u32 v4, v232, v224
  v_lshl_add_u32 v3, v4, 4, v3
  ds_write_b128 v3, v[184:187] offset:6144
  s_cmp_eq_u64 s[42:43], 0
  s_cbranch_scc1 L2_scat_done
  s_mov_b64 exec, s[42:43]
  v_lshrrev_b32 v3, 8, v217
  v_mul_u32_u24 v3, 4608, v3
  v_add_u32 v4, v233, v225
  v_lshl_add_u32 v3, v4, 4, v3
  ds_write_b128 v3, v[188:191] offset:6144
  s_cmp_eq_u64 s[44:45], 0
  s_cbranch_scc1 L2_scat_done
  s_mov_b64 exec, s[44:45]
  v_lshrrev_b32 v3, 8, v218
  v_mul_u32_u24 v3, 4608, v3
  v_add_u32 v4, v234, v226
  v_lshl_add_u32 v3, v4, 4, v3
  ds_write_b128 v3, v[192:195] offset:6144
  s_cmp_eq_u64 s[46:47], 0
  s_cbranch_scc1 L2_scat_done
  s_mov_b64 exec, s[46:47]
  v_lshrrev_b32 v3, 8, v219
  v_mul_u32_u24 v3, 4608, v3
  v_add_u32 v4, v235, v227
  v_lshl_add_u32 v3, v4, 4, v3
  ds_write_b128 v3, v[196:199] offset:6144
  s_cmp_eq_u64 s[48:49], 0
  s_cbranch_scc1 L2_scat_done
  s_mov_b64 exec, s[48:49]
  v_lshrrev_b32 v3, 8, v220
  v_mul_u32_u24 v3, 4608, v3
  v_add_u32 v4, v236, v228
  v_lshl_add_u32 v3, v4, 4, v3
  ds_write_b128 v3, v[200:203] offset:6144
  s_cmp_eq_u64 s[50:51], 0
  s_cbranch_scc1 L2_scat_done
  s_mov_b64 exec, s[50:51]
  v_lshrrev_b32 v3, 8, v221
  v_mul_u32_u24 v3, 4608, v3
  v_add_u32 v4, v237, v229
  v_lshl_add_u32 v3, v4, 4, v3
  ds_write_b128 v3, v[204:207] offset:6144
  s_cmp_eq_u64 s[52:53], 0
  s_cbranch_scc1 L2_scat_done
  s_mov_b64 exec, s[52:53]
  v_lshrrev_b32 v3, 8, v222
  v_mul_u32_u24 v3, 4608, v3
  v_add_u32 v4, v238, v230
  v_lshl_add_u32 v3, v4, 4, v3
  ds_write_b128 v3, v[208:211] offset:6144
  s_cmp_eq_u64 s[54:55], 0
  s_cbranch_scc1 L2_scat_done
  s_mov_b64 exec, s[54:55]
  v_lshrrev_b32 v3, 8, v223
  v_mul_u32_u24 v3, 4608, v3
  v_add_u32 v4, v239, v231
  v_lshl_add_u32 v3, v4, 4, v3
  ds_write_b128 v3, v[212:215] offset:6144
L2_scat_done:
  s_mov_b64 exec, -1
  s_waitcnt lgkmcnt(0)
  s_barrier
  v_lshrrev_b32 v4, 4, v1
  v_bfe_u32 v5, v1, 2, 2
  v_lshl_add_u32 v5, v4, 2, v5
  v_and_b32 v6, 3, v1
  s_lshr_b32 s35, s28, 2
  s_mul_i32 s72, s35, 80
  v_lshl_add_u32 v3, v4, 2, s72
  ds_read_b32 v251, v3 offset:2688
  ds_read_b32 v252, v3 offset:2708
  ds_read_b32 v253, v3 offset:2728
  ds_read_b32 v254, v3 offset:2748
  v_mul_u32_u24 v3, 20, v4
  v_add_u32 v3, s72, v3
  ds_read_b32 v255, v3 offset:2704
  s_mul_i32 s72, s35, 36864
  s_add_u32 s72, s72, 75776
  v_lshl_add_u32 v249, v5, 3, s72
  v_mul_u32_u24 v248, 1088, v6
  v_add_u32 v248, v248, v249
  v_mul_u32_u24 v3, 9216, v6
  v_add_u32 v249, v249, v3
  v_add_u32 v249, 4352, v249
  v_and_b32 v3, 7, v5
  v_lshlrev_b32 v3, 1, v3
  v_lshrrev_b32 v250, 1, v6
  v_xor_b32 v250, v250, v3
  v_lshlrev_b32 v250, 4, v250
  v_and_b32 v3, 1, v6
  v_lshl_add_u32 v250, v3, 3, v250
  v_lshl_add_u32 v250, v5, 8, v250
  v_add_u32 v250, 43008, v250
  s_and_b32 s35, s28, 3
  s_lshl_b32 s72, s35, 6
  v_xor_b32 v250, s72, v250
  s_mul_i32 s72, s2, 625
  s_add_u32 s73, s72, 640
  s_add_u32 s72, s72, 15
  s_lshr_b32 s72, s72, 4
  s_lshr_b32 s73, s73, 4
  s_sub_u32 s73, s73, s72
  s_lshl_b32 s72, s72, 10
  s_lshl_b32 s35, s35, 8
  s_add_u32 s98, s35, s72
  v_and_b32 v5, 15, v1
  v_lshlrev_b32 v5, 4, v5
  s_waitcnt lgkmcnt(0)
  v_cmp_gt_u32 s[88:89], s73, v251
  v_lshl_add_u32 v251, v251, 10, v5
  v_cmp_gt_u32 s[90:91], s73, v252
  v_lshl_add_u32 v252, v252, 10, v5
  v_cmp_gt_u32 s[92:93], s73, v253
  v_lshl_add_u32 v253, v253, 10, v5
  v_cmp_gt_u32 s[94:95], s73, v254
  v_lshl_add_u32 v254, v254, 10, v5
  v_cmp_gt_u32 s[96:97], s73, v255
  v_lshl_add_u32 v255, v255, 10, v5
  s_cmp_eq_u32 s29, 0
  s_cbranch_scc1 L2_loop_exit
  s_add_u32 s30, s29, 3
  s_lshr_b32 s30, s30, 2
  v_lshrrev_b32 v3, 2, v1
  v_lshlrev_b32 v3, 4, v3
  v_add_u32 v10, s17, v3
  ds_read_b128 v[16:19], v10
  v_lshrrev_b32 v3, 1, v1
  v_lshlrev_b32 v3, 4, v3
  v_add_u32 v3, s17, v3
  ds_read_b32 v64, v3 offset:4
  ds_read_b32 v65, v3 offset:516
  ds_read_b32 v66, v3 offset:1028
  ds_read_b32 v67, v3 offset:1540
  v_and_b32 v4, 1, v1
  v_lshlrev_b32 v4, 4, v4
  v_bfe_u32 v5, v1, 3, 2
  v_lshlrev_b32 v5, 2, v5
  v_and_b32 v6, 3, v1
  v_add_u32 v5, v5, v6
  v_lshlrev_b32 v5, 5, v5
  v_lshrrev_b32 v6, 5, v1
  v_lshl_add_u32 v5, v6, 4, v5
  v_add_u32 v5, s16, v5
  v_and_b32 v6, 4, v1
  v_cmp_eq_u32 vcc, 0, v6
  v_mov_b32 v6, 2064
  v_mov_b32 v14, 512
  v_mov_b32 v15, 0
  v_cndmask_b32 v11, v6, v5, vcc
  v_cndmask_b32 v12, v5, v6, vcc
  v_cndmask_b32 v13, v15, v14, vcc
  v_cndmask_b32 v14, v14, v15, vcc
  s_mov_b32 s36, 0
  s_mov_b32 m0, s16
  v_lshrrev_b32 v5, 1, v1
  v_mov_b32 v6, 2147483616
  s_waitcnt lgkmcnt(0)
  s_cmp_le_u32 s29, 128
  s_cbranch_scc1 L2_dma_small
  s_movk_i32 s35, 128
L2_dma_more:
  s_lshl_b32 s72, s35, 4
  v_add_u32 v69, s72, v3
  ds_read_b32 v69, v69 offset:4
  s_lshl_b32 s72, s35, 5
  s_add_u32 m0, s16, s72
  s_waitcnt lgkmcnt(0)
  v_add_u32 v69, v69, v4
  buffer_load_dwordx4 v69, s[4:7], s36 offen sc1 nt lds
  s_add_u32 s35, s35, 32
  s_cmp_lt_u32 s35, s29
  s_cbranch_scc1 L2_dma_more
L2_dma_small:
  v_add_u32 v68, 0, v5
  v_cmp_gt_u32 vcc, s29, v68
  v_add_u32 v64, v64, v4
  s_add_u32 m0, s16, 0
  v_cndmask_b32 v64, v6, v64, vcc
  buffer_load_dwordx4 v64, s[4:7], s36 offen sc1 nt lds
  v_readlane_b32 s56, v16, 0
  s_andn2_b32 s72, s56, 63
  buffer_load_dwordx4 v[184:187], v2, s[8:11], s72 offen
  v_readlane_b32 s57, v16, 4
  s_andn2_b32 s72, s57, 63
  buffer_load_dwordx4 v[188:191], v2, s[8:11], s72 offen
  v_readlane_b32 s58, v16, 8
  s_andn2_b32 s72, s58, 63
  buffer_load_dwordx4 v[192:195], v2, s[8:11], s72 offen
  v_readlane_b32 s59, v16, 12
  s_andn2_b32 s72, s59, 63
  buffer_load_dwordx4 v[196:199], v2, s[8:11], s72 offen
  v_readlane_b32 s60, v16, 16
  s_andn2_b32 s72, s60, 63
  buffer_load_dwordx4 v[200:203], v2, s[8:11], s72 offen
  v_readlane_b32 s61, v16, 20
  s_andn2_b32 s72, s61, 63
  buffer_load_dwordx4 v[204:207], v2, s[8:11], s72 offen
  v_readlane_b32 s62, v16, 24
  s_andn2_b32 s72, s62, 63
  buffer_load_dwordx4 v[208:211], v2, s[8:11], s72 offen
  v_readlane_b32 s63, v16, 28
  s_andn2_b32 s72, s63, 63
  buffer_load_dwordx4 v[212:215], v2, s[8:11], s72 offen
  v_add_u32 v68, 32, v5
  v_cmp_gt_u32 vcc, s29, v68
  v_add_u32 v65, v65, v4
  s_add_u32 m0, s16, 1024
  v_cndmask_b32 v65, v6, v65, vcc
  buffer_load_dwordx4 v65, s[4:7], s36 offen sc1 nt lds
  v_add_u32 v68, 64, v5
  v_cmp_gt_u32 vcc, s29, v68
  v_add_u32 v66, v66, v4
  s_add_u32 m0, s16, 2048
  v_cndmask_b32 v66, v6, v66, vcc
  buffer_load_dwordx4 v66, s[4:7], s36 offen sc1 nt lds
  v_add_u32 v68, 96, v5
  v_cmp_gt_u32 vcc, s29, v68
  v_add_u32 v67, v67, v4
  s_add_u32 m0, s16, 3072
  v_cndmask_b32 v67, v6, v67, vcc
  buffer_load_dwordx4 v67, s[4:7], s36 offen sc1 nt lds
  v_mov_b32 v15, v16
  v_and_b32 v5, 3, v1
  v_lshlrev_b32 v5, 1, v5
  v_add_u32 v5, 149504, v5
  ds_read_u16 v88, v5 offset:4096
  ds_read_u16 v89, v5 offset:4104
  ds_read_u16 v90, v5 offset:4112
  ds_read_u16 v91, v5 offset:4120
  ds_read_u16 v92, v5 offset:4128
  ds_read_u16 v93, v5 offset:4136
  ds_read_u16 v94, v5 offset:4144
  ds_read_u16 v95, v5 offset:4152
  ds_read_u16 v96, v5 offset:4160
  ds_read_u16 v97, v5 offset:4168
  ds_read_u16 v98, v5 offset:4176
  ds_read_u16 v99, v5 offset:4184
  ds_read_u16 v100, v5 offset:4192
  ds_read_u16 v101, v5 offset:4200
  ds_read_u16 v102, v5 offset:4208
  ds_read_u16 v103, v5 offset:4216
  s_waitcnt lgkmcnt(0)
  v_lshl_or_b32 v32, v89, 16, v88
  v_lshl_or_b32 v33, v91, 16, v90
  v_lshl_or_b32 v34, v93, 16, v92
  v_lshl_or_b32 v35, v95, 16, v94
  v_lshl_or_b32 v36, v97, 16, v96
  v_lshl_or_b32 v37, v99, 16, v98
  v_lshl_or_b32 v38, v101, 16, v100
  v_lshl_or_b32 v39, v103, 16, v102
  v_lshrrev_b32 v4, 5, v1
  v_lshlrev_b32 v4, 11, v4
  v_and_b32 v5, 31, v1
  v_lshl_add_u32 v4, v5, 2, v4
  v_add_u32 v4, 149504, v4
  ds_read_b32 v72, v4 offset:0
  ds_read_b32 v73, v4 offset:256
  ds_read_b32 v74, v4 offset:512
  ds_read_b32 v75, v4 offset:768
  ds_read_b32 v76, v4 offset:1024
  ds_read_b32 v77, v4 offset:1280
  ds_read_b32 v78, v4 offset:1536
  ds_read_b32 v79, v4 offset:1792
  ds_read_b32 v80, v4 offset:128
  ds_read_b32 v81, v4 offset:384
  ds_read_b32 v82, v4 offset:640
  ds_read_b32 v83, v4 offset:896
  ds_read_b32 v84, v4 offset:1152
  ds_read_b32 v85, v4 offset:1408
  ds_read_b32 v86, v4 offset:1664
  ds_read_b32 v87, v4 offset:1920
  s_waitcnt lgkmcnt(0)
  v_perm_b32 v40, v73, v72, s78
  v_perm_b32 v41, v75, v74, s78
  v_perm_b32 v42, v77, v76, s78
  v_perm_b32 v43, v79, v78, s78
  v_perm_b32 v44, v81, v80, s78
  v_perm_b32 v45, v83, v82, s78
  v_perm_b32 v46, v85, v84, s78
  v_perm_b32 v47, v87, v86, s78
  v_perm_b32 v48, v73, v72, s79
  v_perm_b32 v49, v75, v74, s79
  v_perm_b32 v50, v77, v76, s79
  v_perm_b32 v51, v79, v78, s79
  v_perm_b32 v52, v81, v80, s79
  v_perm_b32 v53, v83, v82, s79
  v_perm_b32 v54, v85, v84, s79
  v_perm_b32 v55, v87, v86, s79
  v_dot2_f32_bf16 v216, v19, v33, 0
  v_dot2_f32_bf16 v217, v19, v35, 0
  v_dot2_f32_bf16 v218, v19, v37, 0
  v_dot2_f32_bf16 v219, v19, v39, 0
  v_dot2_f32_bf16 v216, v18, v32, v216
  v_dot2_f32_bf16 v217, v18, v34, v217
  v_dot2_f32_bf16 v218, v18, v36, v218
  v_dot2_f32_bf16 v219, v18, v38, v219
  s_nop 2
  v_cvt_pk_bf16_f32 v20, v216, v217
  v_cvt_pk_bf16_f32 v21, v218, v219
  v_add_u32 v10, 256, v10
  s_waitcnt vmcnt(11)
  ds_read_b128 v[24:27], v11
  ds_read_b128 v[28:31], v12
  v_add_u32 v11, v11, v13
  v_add_u32 v12, v12, v14
  s_waitcnt lgkmcnt(0)
  v_mfma_f32_32x32x16_bf16 v[72:87], v[24:27], v[40:43], 0
  v_mfma_f32_32x32x16_bf16 v[72:87], v[28:31], v[44:47], v[72:87]
  v_mfma_f32_32x32x16_bf16 v[88:103], v[24:27], v[48:51], 0
  v_mfma_f32_32x32x16_bf16 v[88:103], v[28:31], v[52:55], v[88:103]
  s_nop 7
  ds_read_b128 v[24:27], v11
  ds_read_b128 v[28:31], v12
  v_add_u32 v11, v11, v13
  v_add_u32 v12, v12, v14
  s_nop 7
  s_cmp_ge_u32 s28, 4
  s_cbranch_scc1 L2_pl_0_0_1
  s_setprio 1
  s_branch L2_ph_0_0_1
L2_pl_0_0_1:
  s_setprio 0
L2_ph_0_0_1:
  s_waitcnt lgkmcnt(0)
  ds_read_b128 v[16:19], v10
  v_pk_mul_f32 v[64:65], v[72:73], s[38:39]
  v_pk_mul_f32 v[66:67], v[74:75], s[38:39]
  v_pk_mul_f32 v[68:69], v[88:89], s[38:39]
  v_pk_mul_f32 v[70:71], v[90:91], s[38:39]
  v_exp_f32 v64, v64
  v_mfma_f32_32x32x16_bf16 v[104:119], v[24:27], v[40:43], 0
  v_exp_f32 v65, v65
  v_exp_f32 v66, v66
  v_exp_f32 v67, v67
  v_exp_f32 v68, v68
  v_exp_f32 v69, v69
  v_exp_f32 v70, v70
  v_exp_f32 v71, v71
  v_pk_add_f32 v[64:65], v[64:65], 1.0 op_sel_hi:[1,0]
  v_pk_add_f32 v[66:67], v[66:67], 1.0 op_sel_hi:[1,0]
  v_pk_add_f32 v[68:69], v[68:69], 1.0 op_sel_hi:[1,0]
  v_pk_add_f32 v[70:71], v[70:71], 1.0 op_sel_hi:[1,0]
  v_readlane_b32 s64, v15, 32
  v_readlane_b32 s65, v15, 36
  v_readlane_b32 s66, v15, 40
  v_readlane_b32 s67, v15, 44
  s_waitcnt vmcnt(7)
  v_mfma_f32_4x4x4_16b_bf16 v[216:219], v[20:21], v[184:185], 0 cbsz:4 abid:0
  v_rcp_f32 v64, v64
  v_mfma_f32_4x4x4_16b_bf16 v[220:223], v[20:21], v[186:187], 0 cbsz:4 abid:0
  v_rcp_f32 v65, v65
  v_mfma_f32_4x4x4_16b_bf16 v[224:227], v[20:21], v[188:189], 0 cbsz:4 abid:1
  v_rcp_f32 v66, v66
  v_mfma_f32_4x4x4_16b_bf16 v[228:231], v[20:21], v[190:191], 0 cbsz:4 abid:1
  v_rcp_f32 v67, v67
  v_mfma_f32_4x4x4_16b_bf16 v[232:235], v[20:21], v[192:193], 0 cbsz:4 abid:2
  v_rcp_f32 v68, v68
  v_mfma_f32_4x4x4_16b_bf16 v[236:239], v[20:21], v[194:195], 0 cbsz:4 abid:2
  v_rcp_f32 v69, v69
  v_mfma_f32_4x4x4_16b_bf16 v[240:243], v[20:21], v[196:197], 0 cbsz:4 abid:3
  v_rcp_f32 v70, v70
  v_mfma_f32_4x4x4_16b_bf16 v[244:247], v[20:21], v[198:199], 0 cbsz:4 abid:3
  v_rcp_f32 v71, v71
  s_andn2_b32 s72, s64, 63
  s_andn2_b32 s73, s65, 63
  s_andn2_b32 s74, s66, 63
  s_andn2_b32 s75, s67, 63
  buffer_load_dwordx4 v[184:187], v2, s[8:11], s72 offen
  buffer_load_dwordx4 v[188:191], v2, s[8:11], s73 offen
  buffer_load_dwordx4 v[192:195], v2, s[8:11], s74 offen
  buffer_load_dwordx4 v[196:199], v2, s[8:11], s75 offen
  v_pk_mul_f32 v[56:57], v[72:73], v[64:65]
  v_pk_mul_f32 v[58:59], v[74:75], v[66:67]
  v_pk_mul_f32 v[60:61], v[88:89], v[68:69]
  v_pk_mul_f32 v[62:63], v[90:91], v[70:71]
  s_set_gpr_idx_on s56, gpr_idx(SRC2,DST)
  v_pk_fma_f32 v[136:137], v[216:217], v[56:57], v[136:137] op_sel:[0,0,0] op_sel_hi:[1,0,1]
  v_pk_fma_f32 v[138:139], v[218:219], v[56:57], v[138:139] op_sel:[0,0,0] op_sel_hi:[1,0,1]
  v_pk_fma_f32 v[140:141], v[220:221], v[60:61], v[140:141] op_sel:[0,0,0] op_sel_hi:[1,0,1]
  v_pk_fma_f32 v[142:143], v[222:223], v[60:61], v[142:143] op_sel:[0,0,0] op_sel_hi:[1,0,1]
  s_set_gpr_idx_idx s57
  v_pk_fma_f32 v[136:137], v[224:225], v[56:57], v[136:137] op_sel:[0,1,0] op_sel_hi:[1,1,1]
  v_pk_fma_f32 v[138:139], v[226:227], v[56:57], v[138:139] op_sel:[0,1,0] op_sel_hi:[1,1,1]
  v_pk_fma_f32 v[140:141], v[228:229], v[60:61], v[140:141] op_sel:[0,1,0] op_sel_hi:[1,1,1]
  v_pk_fma_f32 v[142:143], v[230:231], v[60:61], v[142:143] op_sel:[0,1,0] op_sel_hi:[1,1,1]
  s_set_gpr_idx_idx s58
  v_pk_fma_f32 v[136:137], v[232:233], v[58:59], v[136:137] op_sel:[0,0,0] op_sel_hi:[1,0,1]
  v_pk_fma_f32 v[138:139], v[234:235], v[58:59], v[138:139] op_sel:[0,0,0] op_sel_hi:[1,0,1]
  v_pk_fma_f32 v[140:141], v[236:237], v[62:63], v[140:141] op_sel:[0,0,0] op_sel_hi:[1,0,1]
  v_pk_fma_f32 v[142:143], v[238:239], v[62:63], v[142:143] op_sel:[0,0,0] op_sel_hi:[1,0,1]
  s_set_gpr_idx_idx s59
  v_pk_fma_f32 v[136:137], v[240:241], v[58:59], v[136:137] op_sel:[0,1,0] op_sel_hi:[1,1,1]
  v_pk_fma_f32 v[138:139], v[242:243], v[58:59], v[138:139] op_sel:[0,1,0] op_sel_hi:[1,1,1]
  v_pk_fma_f32 v[140:141], v[244:245], v[62:63], v[140:141] op_sel:[0,1,0] op_sel_hi:[1,1,1]
  v_pk_fma_f32 v[142:143], v[246:247], v[62:63], v[142:143] op_sel:[0,1,0] op_sel_hi:[1,1,1]
  s_set_gpr_idx_off
  s_sub_u32 s30, s30, 1
  s_cmp_eq_u32 s30, 0
  s_cbranch_scc1 L2_loop_exit
  s_waitcnt lgkmcnt(0)
  v_pk_mul_f32 v[64:65], v[76:77], s[38:39]
  v_pk_mul_f32 v[66:67], v[78:79], s[38:39]
  v_pk_mul_f32 v[68:69], v[92:93], s[38:39]
  v_pk_mul_f32 v[70:71], v[94:95], s[38:39]
  v_exp_f32 v64, v64
  v_mfma_f32_32x32x16_bf16 v[104:119], v[28:31], v[44:47], v[104:119]
  v_exp_f32 v65, v65
  v_exp_f32 v66, v66
  v_exp_f32 v67, v67
  v_exp_f32 v68, v68
  v_exp_f32 v69, v69
  v_exp_f32 v70, v70
  v_exp_f32 v71, v71
  v_pk_add_f32 v[64:65], v[64:65], 1.0 op_sel_hi:[1,0]
  v_pk_add_f32 v[66:67], v[66:67], 1.0 op_sel_hi:[1,0]
  v_pk_add_f32 v[68:69], v[68:69], 1.0 op_sel_hi:[1,0]
  v_pk_add_f32 v[70:71], v[70:71], 1.0 op_sel_hi:[1,0]
  v_readlane_b32 s68, v15, 48
  v_readlane_b32 s69, v15, 52
  v_readlane_b32 s70, v15, 56
  v_readlane_b32 s71, v15, 60
  v_dot2_f32_bf16 v216, v19, v33, 0
  v_dot2_f32_bf16 v217, v19, v35, 0
  v_dot2_f32_bf16 v218, v19, v37, 0
  v_dot2_f32_bf16 v219, v19, v39, 0
  v_dot2_f32_bf16 v216, v18, v32, v216
  v_dot2_f32_bf16 v217, v18, v34, v217
  v_dot2_f32_bf16 v218, v18, v36, v218
  v_dot2_f32_bf16 v219, v18, v38, v219
  s_nop 2
  v_cvt_pk_bf16_f32 v22, v216, v217
  v_cvt_pk_bf16_f32 v23, v218, v219
  s_waitcnt vmcnt(7)
  v_mfma_f32_4x4x4_16b_bf16 v[216:219], v[20:21], v[200:201], 0 cbsz:4 abid:4
  v_rcp_f32 v64, v64
  v_mfma_f32_4x4x4_16b_bf16 v[220:223], v[20:21], v[202:203], 0 cbsz:4 abid:4
  v_rcp_f32 v65, v65
  v_mfma_f32_4x4x4_16b_bf16 v[224:227], v[20:21], v[204:205], 0 cbsz:4 abid:5
  v_rcp_f32 v66, v66
  v_mfma_f32_4x4x4_16b_bf16 v[228:231], v[20:21], v[206:207], 0 cbsz:4 abid:5
  v_rcp_f32 v67, v67
  v_mfma_f32_4x4x4_16b_bf16 v[232:235], v[20:21], v[208:209], 0 cbsz:4 abid:6
  v_rcp_f32 v68, v68
  v_mfma_f32_4x4x4_16b_bf16 v[236:239], v[20:21], v[210:211], 0 cbsz:4 abid:6
  v_rcp_f32 v69, v69
  v_mfma_f32_4x4x4_16b_bf16 v[240:243], v[20:21], v[212:213], 0 cbsz:4 abid:7
  v_rcp_f32 v70, v70
  v_mfma_f32_4x4x4_16b_bf16 v[244:247], v[20:21], v[214:215], 0 cbsz:4 abid:7
  v_rcp_f32 v71, v71
  s_andn2_b32 s72, s68, 63
  s_andn2_b32 s73, s69, 63
  s_andn2_b32 s74, s70, 63
  s_andn2_b32 s75, s71, 63
  buffer_load_dwordx4 v[200:203], v2, s[8:11], s72 offen
  buffer_load_dwordx4 v[204:207], v2, s[8:11], s73 offen
  buffer_load_dwordx4 v[208:211], v2, s[8:11], s74 offen
  buffer_load_dwordx4 v[212:215], v2, s[8:11], s75 offen
  v_pk_mul_f32 v[56:57], v[76:77], v[64:65]
  v_pk_mul_f32 v[58:59], v[78:79], v[66:67]
  v_pk_mul_f32 v[60:61], v[92:93], v[68:69]
  v_pk_mul_f32 v[62:63], v[94:95], v[70:71]
  s_set_gpr_idx_on s60, gpr_idx(SRC2,DST)
  v_pk_fma_f32 v[136:137], v[216:217], v[56:57], v[136:137] op_sel:[0,0,0] op_sel_hi:[1,0,1]
  v_pk_fma_f32 v[138:139], v[218:219], v[56:57], v[138:139] op_sel:[0,0,0] op_sel_hi:[1,0,1]
  v_pk_fma_f32 v[140:141], v[220:221], v[60:61], v[140:141] op_sel:[0,0,0] op_sel_hi:[1,0,1]
  v_pk_fma_f32 v[142:143], v[222:223], v[60:61], v[142:143] op_sel:[0,0,0] op_sel_hi:[1,0,1]
  s_set_gpr_idx_idx s61
  v_pk_fma_f32 v[136:137], v[224:225], v[56:57], v[136:137] op_sel:[0,1,0] op_sel_hi:[1,1,1]
  v_pk_fma_f32 v[138:139], v[226:227], v[56:57], v[138:139] op_sel:[0,1,0] op_sel_hi:[1,1,1]
  v_pk_fma_f32 v[140:141], v[228:229], v[60:61], v[140:141] op_sel:[0,1,0] op_sel_hi:[1,1,1]
  v_pk_fma_f32 v[142:143], v[230:231], v[60:61], v[142:143] op_sel:[0,1,0] op_sel_hi:[1,1,1]
  s_set_gpr_idx_idx s62
  v_pk_fma_f32 v[136:137], v[232:233], v[58:59], v[136:137] op_sel:[0,0,0] op_sel_hi:[1,0,1]
  v_pk_fma_f32 v[138:139], v[234:235], v[58:59], v[138:139] op_sel:[0,0,0] op_sel_hi:[1,0,1]
  v_pk_fma_f32 v[140:141], v[236:237], v[62:63], v[140:141] op_sel:[0,0,0] op_sel_hi:[1,0,1]
  v_pk_fma_f32 v[142:143], v[238:239], v[62:63], v[142:143] op_sel:[0,0,0] op_sel_hi:[1,0,1]
  s_set_gpr_idx_idx s63
  v_pk_fma_f32 v[136:137], v[240:241], v[58:59], v[136:137] op_sel:[0,1,0] op_sel_hi:[1,1,1]
  v_pk_fma_f32 v[138:139], v[242:243], v[58:59], v[138:139] op_sel:[0,1,0] op_sel_hi:[1,1,1]
  v_pk_fma_f32 v[140:141], v[244:245], v[62:63], v[140:141] op_sel:[0,1,0] op_sel_hi:[1,1,1]
  v_pk_fma_f32 v[142:143], v[246:247], v[62:63], v[142:143] op_sel:[0,1,0] op_sel_hi:[1,1,1]
  s_set_gpr_idx_off
  s_sub_u32 s30, s30, 1
  s_cmp_eq_u32 s30, 0
  s_cbranch_scc1 L2_loop_exit
  v_pk_mul_f32 v[64:65], v[80:81], s[38:39]
  v_pk_mul_f32 v[66:67], v[82:83], s[38:39]
  v_pk_mul_f32 v[68:69], v[96:97], s[38:39]
  v_pk_mul_f32 v[70:71], v[98:99], s[38:39]
  v_exp_f32 v64, v64
  v_mfma_f32_32x32x16_bf16 v[120:135], v[24:27], v[48:51], 0
  v_exp_f32 v65, v65
  v_exp_f32 v66, v66
  v_exp_f32 v67, v67
  v_exp_f32 v68, v68
  v_exp_f32 v69, v69
  v_exp_f32 v70, v70
  v_exp_f32 v71, v71
  v_pk_add_f32 v[64:65], v[64:65], 1.0 op_sel_hi:[1,0]
  v_pk_add_f32 v[66:67], v[66:67], 1.0 op_sel_hi:[1,0]
  v_pk_add_f32 v[68:69], v[68:69], 1.0 op_sel_hi:[1,0]
  v_pk_add_f32 v[70:71], v[70:71], 1.0 op_sel_hi:[1,0]
  v_readlane_b32 s56, v16, 0
  v_readlane_b32 s57, v16, 4
  v_readlane_b32 s58, v16, 8
  v_readlane_b32 s59, v16, 12
  s_waitcnt vmcnt(4)
  v_mfma_f32_4x4x4_16b_bf16 v[216:219], v[20:21], v[184:185], 0 cbsz:4 abid:8
  v_rcp_f32 v64, v64
  v_mfma_f32_4x4x4_16b_bf16 v[220:223], v[20:21], v[186:187], 0 cbsz:4 abid:8
  v_rcp_f32 v65, v65
  v_mfma_f32_4x4x4_16b_bf16 v[224:227], v[20:21], v[188:189], 0 cbsz:4 abid:9
  v_rcp_f32 v66, v66
  v_mfma_f32_4x4x4_16b_bf16 v[228:231], v[20:21], v[190:191], 0 cbsz:4 abid:9
  v_rcp_f32 v67, v67
  v_mfma_f32_4x4x4_16b_bf16 v[232:235], v[20:21], v[192:193], 0 cbsz:4 abid:10
  v_rcp_f32 v68, v68
  v_mfma_f32_4x4x4_16b_bf16 v[236:239], v[20:21], v[194:195], 0 cbsz:4 abid:10
  v_rcp_f32 v69, v69
  v_mfma_f32_4x4x4_16b_bf16 v[240:243], v[20:21], v[196:197], 0 cbsz:4 abid:11
  v_rcp_f32 v70, v70
  v_mfma_f32_4x4x4_16b_bf16 v[244:247], v[20:21], v[198:199], 0 cbsz:4 abid:11
  v_rcp_f32 v71, v71
  s_andn2_b32 s72, s56, 63
  s_andn2_b32 s73, s57, 63
  s_andn2_b32 s74, s58, 63
  s_andn2_b32 s75, s59, 63
  buffer_load_dwordx4 v[184:187], v2, s[8:11], s72 offen
  buffer_load_dwordx4 v[188:191], v2, s[8:11], s73 offen
  buffer_load_dwordx4 v[192:195], v2, s[8:11], s74 offen
  buffer_load_dwordx4 v[196:199], v2, s[8:11], s75 offen
  v_pk_mul_f32 v[56:57], v[80:81], v[64:65]
  v_pk_mul_f32 v[58:59], v[82:83], v[66:67]
  v_pk_mul_f32 v[60:61], v[96:97], v[68:69]
  v_pk_mul_f32 v[62:63], v[98:99], v[70:71]
  s_set_gpr_idx_on s64, gpr_idx(SRC2,DST)
  v_pk_fma_f32 v[136:137], v[216:217], v[56:57], v[136:137] op_sel:[0,0,0] op_sel_hi:[1,0,1]
  v_pk_fma_f32 v[138:139], v[218:219], v[56:57], v[138:139] op_sel:[0,0,0] op_sel_hi:[1,0,1]
  v_pk_fma_f32 v[140:141], v[220:221], v[60:61], v[140:141] op_sel:[0,0,0] op_sel_hi:[1,0,1]
  v_pk_fma_f32 v[142:143], v[222:223], v[60:61], v[142:143] op_sel:[0,0,0] op_sel_hi:[1,0,1]
  s_set_gpr_idx_idx s65
  v_pk_fma_f32 v[136:137], v[224:225], v[56:57], v[136:137] op_sel:[0,1,0] op_sel_hi:[1,1,1]
  v_pk_fma_f32 v[138:139], v[226:227], v[56:57], v[138:139] op_sel:[0,1,0] op_sel_hi:[1,1,1]
  v_pk_fma_f32 v[140:141], v[228:229], v[60:61], v[140:141] op_sel:[0,1,0] op_sel_hi:[1,1,1]
  v_pk_fma_f32 v[142:143], v[230:231], v[60:61], v[142:143] op_sel:[0,1,0] op_sel_hi:[1,1,1]
  s_set_gpr_idx_idx s66
  v_pk_fma_f32 v[136:137], v[232:233], v[58:59], v[136:137] op_sel:[0,0,0] op_sel_hi:[1,0,1]
  v_pk_fma_f32 v[138:139], v[234:235], v[58:59], v[138:139] op_sel:[0,0,0] op_sel_hi:[1,0,1]
  v_pk_fma_f32 v[140:141], v[236:237], v[62:63], v[140:141] op_sel:[0,0,0] op_sel_hi:[1,0,1]
  v_pk_fma_f32 v[142:143], v[238:239], v[62:63], v[142:143] op_sel:[0,0,0] op_sel_hi:[1,0,1]
  s_set_gpr_idx_idx s67
  v_pk_fma_f32 v[136:137], v[240:241], v[58:59], v[136:137] op_sel:[0,1,0] op_sel_hi:[1,1,1]
  v_pk_fma_f32 v[138:139], v[242:243], v[58:59], v[138:139] op_sel:[0,1,0] op_sel_hi:[1,1,1]
  v_pk_fma_f32 v[140:141], v[244:245], v[62:63], v[140:141] op_sel:[0,1,0] op_sel_hi:[1,1,1]
  v_pk_fma_f32 v[142:143], v[246:247], v[62:63], v[142:143] op_sel:[0,1,0] op_sel_hi:[1,1,1]
  s_set_gpr_idx_off
  s_sub_u32 s30, s30, 1
  s_cmp_eq_u32 s30, 0
  s_cbranch_scc1 L2_loop_exit
  v_pk_mul_f32 v[64:65], v[84:85], s[38:39]
  v_pk_mul_f32 v[66:67], v[86:87], s[38:39]
  v_pk_mul_f32 v[68:69], v[100:101], s[38:39]
  v_pk_mul_f32 v[70:71], v[102:103], s[38:39]
  v_exp_f32 v64, v64
  v_mfma_f32_32x32x16_bf16 v[120:135], v[28:31], v[52:55], v[120:135]
  v_exp_f32 v65, v65
  v_exp_f32 v66, v66
  v_exp_f32 v67, v67
  v_exp_f32 v68, v68
  v_exp_f32 v69, v69
  v_exp_f32 v70, v70
  v_exp_f32 v71, v71
  v_pk_add_f32 v[64:65], v[64:65], 1.0 op_sel_hi:[1,0]
  v_pk_add_f32 v[66:67], v[66:67], 1.0 op_sel_hi:[1,0]
  v_pk_add_f32 v[68:69], v[68:69], 1.0 op_sel_hi:[1,0]
  v_pk_add_f32 v[70:71], v[70:71], 1.0 op_sel_hi:[1,0]
  v_readlane_b32 s60, v16, 16
  v_readlane_b32 s61, v16, 20
  v_readlane_b32 s62, v16, 24
  v_readlane_b32 s63, v16, 28
  s_waitcnt vmcnt(4)
  ds_read_b128 v[24:27], v11
  ds_read_b128 v[28:31], v12
  v_add_u32 v11, v11, v13
  v_add_u32 v12, v12, v14
  v_mfma_f32_4x4x4_16b_bf16 v[216:219], v[20:21], v[200:201], 0 cbsz:4 abid:12
  v_rcp_f32 v64, v64
  v_mfma_f32_4x4x4_16b_bf16 v[220:223], v[20:21], v[202:203], 0 cbsz:4 abid:12
  v_rcp_f32 v65, v65
  v_mfma_f32_4x4x4_16b_bf16 v[224:227], v[20:21], v[204:205], 0 cbsz:4 abid:13
  v_rcp_f32 v66, v66
  v_mfma_f32_4x4x4_16b_bf16 v[228:231], v[20:21], v[206:207], 0 cbsz:4 abid:13
  v_rcp_f32 v67, v67
  v_mfma_f32_4x4x4_16b_bf16 v[232:235], v[20:21], v[208:209], 0 cbsz:4 abid:14
  v_rcp_f32 v68, v68
  v_mfma_f32_4x4x4_16b_bf16 v[236:239], v[20:21], v[210:211], 0 cbsz:4 abid:14
  v_rcp_f32 v69, v69
  v_mfma_f32_4x4x4_16b_bf16 v[240:243], v[20:21], v[212:213], 0 cbsz:4 abid:15
  v_rcp_f32 v70, v70
  v_mfma_f32_4x4x4_16b_bf16 v[244:247], v[20:21], v[214:215], 0 cbsz:4 abid:15
  v_rcp_f32 v71, v71
  s_andn2_b32 s72, s60, 63
  s_andn2_b32 s73, s61, 63
  s_andn2_b32 s74, s62, 63
  s_andn2_b32 s75, s63, 63
  buffer_load_dwordx4 v[200:203], v2, s[8:11], s72 offen
  buffer_load_dwordx4 v[204:207], v2, s[8:11], s73 offen
  buffer_load_dwordx4 v[208:211], v2, s[8:11], s74 offen
  buffer_load_dwordx4 v[212:215], v2, s[8:11], s75 offen
  v_pk_mul_f32 v[56:57], v[84:85], v[64:65]
  v_pk_mul_f32 v[58:59], v[86:87], v[66:67]
  v_pk_mul_f32 v[60:61], v[100:101], v[68:69]
  v_pk_mul_f32 v[62:63], v[102:103], v[70:71]
  s_set_gpr_idx_on s68, gpr_idx(SRC2,DST)
  v_pk_fma_f32 v[136:137], v[216:217], v[56:57], v[136:137] op_sel:[0,0,0] op_sel_hi:[1,0,1]
  v_pk_fma_f32 v[138:139], v[218:219], v[56:57], v[138:139] op_sel:[0,0,0] op_sel_hi:[1,0,1]
  v_pk_fma_f32 v[140:141], v[220:221], v[60:61], v[140:141] op_sel:[0,0,0] op_sel_hi:[1,0,1]
  v_pk_fma_f32 v[142:143], v[222:223], v[60:61], v[142:143] op_sel:[0,0,0] op_sel_hi:[1,0,1]
  s_set_gpr_idx_idx s69
  v_pk_fma_f32 v[136:137], v[224:225], v[56:57], v[136:137] op_sel:[0,1,0] op_sel_hi:[1,1,1]
  v_pk_fma_f32 v[138:139], v[226:227], v[56:57], v[138:139] op_sel:[0,1,0] op_sel_hi:[1,1,1]
  v_pk_fma_f32 v[140:141], v[228:229], v[60:61], v[140:141] op_sel:[0,1,0] op_sel_hi:[1,1,1]
  v_pk_fma_f32 v[142:143], v[230:231], v[60:61], v[142:143] op_sel:[0,1,0] op_sel_hi:[1,1,1]
  s_set_gpr_idx_idx s70
  v_pk_fma_f32 v[136:137], v[232:233], v[58:59], v[136:137] op_sel:[0,0,0] op_sel_hi:[1,0,1]
  v_pk_fma_f32 v[138:139], v[234:235], v[58:59], v[138:139] op_sel:[0,0,0] op_sel_hi:[1,0,1]
  v_pk_fma_f32 v[140:141], v[236:237], v[62:63], v[140:141] op_sel:[0,0,0] op_sel_hi:[1,0,1]
  v_pk_fma_f32 v[142:143], v[238:239], v[62:63], v[142:143] op_sel:[0,0,0] op_sel_hi:[1,0,1]
  s_set_gpr_idx_idx s71
  v_pk_fma_f32 v[136:137], v[240:241], v[58:59], v[136:137] op_sel:[0,1,0] op_sel_hi:[1,1,1]
  v_pk_fma_f32 v[138:139], v[242:243], v[58:59], v[138:139] op_sel:[0,1,0] op_sel_hi:[1,1,1]
  v_pk_fma_f32 v[140:141], v[244:245], v[62:63], v[140:141] op_sel:[0,1,0] op_sel_hi:[1,1,1]
  v_pk_fma_f32 v[142:143], v[246:247], v[62:63], v[142:143] op_sel:[0,1,0] op_sel_hi:[1,1,1]
  s_set_gpr_idx_off
  v_mov_b32 v20, v22
  v_mov_b32 v21, v23
  v_mov_b32 v15, v16
  v_add_u32 v10, 256, v10
  s_sub_u32 s30, s30, 1
  s_cmp_eq_u32 s30, 0
  s_cbranch_scc1 L2_loop_exit
L2_batch1:
  s_cmp_ge_u32 s28, 4
  s_cbranch_scc0 L2_pl_1_0_0
  s_setprio 1
  s_branch L2_ph_1_0_0
L2_pl_1_0_0:
  s_setprio 0
L2_ph_1_0_0:
  s_waitcnt lgkmcnt(0)
  ds_read_b128 v[16:19], v10
  v_pk_mul_f32 v[64:65], v[104:105], s[38:39]
  v_pk_mul_f32 v[66:67], v[106:107], s[38:39]
  v_pk_mul_f32 v[68:69], v[120:121], s[38:39]
  v_pk_mul_f32 v[70:71], v[122:123], s[38:39]
  v_exp_f32 v64, v64
  v_mfma_f32_32x32x16_bf16 v[72:87], v[24:27], v[40:43], 0
  v_exp_f32 v65, v65
  v_exp_f32 v66, v66
  v_exp_f32 v67, v67
  v_exp_f32 v68, v68
  v_exp_f32 v69, v69
  v_exp_f32 v70, v70
  v_exp_f32 v71, v71
  v_pk_add_f32 v[64:65], v[64:65], 1.0 op_sel_hi:[1,0]
  v_pk_add_f32 v[66:67], v[66:67], 1.0 op_sel_hi:[1,0]
  v_pk_add_f32 v[68:69], v[68:69], 1.0 op_sel_hi:[1,0]
  v_pk_add_f32 v[70:71], v[70:71], 1.0 op_sel_hi:[1,0]
  v_readlane_b32 s64, v15, 32
  v_readlane_b32 s65, v15, 36
  v_readlane_b32 s66, v15, 40
  v_readlane_b32 s67, v15, 44
  s_waitcnt vmcnt(4)
  v_mfma_f32_4x4x4_16b_bf16 v[216:219], v[20:21], v[184:185], 0 cbsz:4 abid:0
  v_rcp_f32 v64, v64
  v_mfma_f32_4x4x4_16b_bf16 v[220:223], v[20:21], v[186:187], 0 cbsz:4 abid:0
  v_rcp_f32 v65, v65
  v_mfma_f32_4x4x4_16b_bf16 v[224:227], v[20:21], v[188:189], 0 cbsz:4 abid:1
  v_rcp_f32 v66, v66
  v_mfma_f32_4x4x4_16b_bf16 v[228:231], v[20:21], v[190:191], 0 cbsz:4 abid:1
  v_rcp_f32 v67, v67
  v_mfma_f32_4x4x4_16b_bf16 v[232:235], v[20:21], v[192:193], 0 cbsz:4 abid:2
  v_rcp_f32 v68, v68
  v_mfma_f32_4x4x4_16b_bf16 v[236:239], v[20:21], v[194:195], 0 cbsz:4 abid:2
  v_rcp_f32 v69, v69
  v_mfma_f32_4x4x4_16b_bf16 v[240:243], v[20:21], v[196:197], 0 cbsz:4 abid:3
  v_rcp_f32 v70, v70
  v_mfma_f32_4x4x4_16b_bf16 v[244:247], v[20:21], v[198:199], 0 cbsz:4 abid:3
  v_rcp_f32 v71, v71
  s_andn2_b32 s72, s64, 63
  s_andn2_b32 s73, s65, 63
  s_andn2_b32 s74, s66, 63
  s_andn2_b32 s75, s67, 63
  buffer_load_dwordx4 v[184:187], v2, s[8:11], s72 offen
  buffer_load_dwordx4 v[188:191], v2, s[8:11], s73 offen
  buffer_load_dwordx4 v[192:195], v2, s[8:11], s74 offen
  buffer_load_dwordx4 v[196:199], v2, s[8:11], s75 offen
  v_pk_mul_f32 v[56:57], v[104:105], v[64:65]
  v_pk_mul_f32 v[58:59], v[106:107], v[66:67]
  v_pk_mul_f32 v[60:61], v[120:121], v[68:69]
  v_pk_mul_f32 v[62:63], v[122:123], v[70:71]
  s_set_gpr_idx_on s56, gpr_idx(SRC2,DST)
  v_pk_fma_f32 v[136:137], v[216:217], v[56:57], v[136:137] op_sel:[0,0,0] op_sel_hi:[1,0,1]
  v_pk_fma_f32 v[138:139], v[218:219], v[56:57], v[138:139] op_sel:[0,0,0] op_sel_hi:[1,0,1]
  v_pk_fma_f32 v[140:141], v[220:221], v[60:61], v[140:141] op_sel:[0,0,0] op_sel_hi:[1,0,1]
  v_pk_fma_f32 v[142:143], v[222:223], v[60:61], v[142:143] op_sel:[0,0,0] op_sel_hi:[1,0,1]
  s_set_gpr_idx_idx s57
  v_pk_fma_f32 v[136:137], v[224:225], v[56:57], v[136:137] op_sel:[0,1,0] op_sel_hi:[1,1,1]
  v_pk_fma_f32 v[138:139], v[226:227], v[56:57], v[138:139] op_sel:[0,1,0] op_sel_hi:[1,1,1]
  v_pk_fma_f32 v[140:141], v[228:229], v[60:61], v[140:141] op_sel:[0,1,0] op_sel_hi:[1,1,1]
  v_pk_fma_f32 v[142:143], v[230:231], v[60:61], v[142:143] op_sel:[0,1,0] op_sel_hi:[1,1,1]
  s_set_gpr_idx_idx s58
  v_pk_fma_f32 v[136:137], v[232:233], v[58:59], v[136:137] op_sel:[0,0,0] op_sel_hi:[1,0,1]
  v_pk_fma_f32 v[138:139], v[234:235], v[58:59], v[138:139] op_sel:[0,0,0] op_sel_hi:[1,0,1]
  v_pk_fma_f32 v[140:141], v[236:237], v[62:63], v[140:141] op_sel:[0,0,0] op_sel_hi:[1,0,1]
  v_pk_fma_f32 v[142:143], v[238:239], v[62:63], v[142:143] op_sel:[0,0,0] op_sel_hi:[1,0,1]
  s_set_gpr_idx_idx s59
  v_pk_fma_f32 v[136:137], v[240:241], v[58:59], v[136:137] op_sel:[0,1,0] op_sel_hi:[1,1,1]
  v_pk_fma_f32 v[138:139], v[242:243], v[58:59], v[138:139] op_sel:[0,1,0] op_sel_hi:[1,1,1]
  v_pk_fma_f32 v[140:141], v[244:245], v[62:63], v[140:141] op_sel:[0,1,0] op_sel_hi:[1,1,1]
  v_pk_fma_f32 v[142:143], v[246:247], v[62:63], v[142:143] op_sel:[0,1,0] op_sel_hi:[1,1,1]
  s_set_gpr_idx_off
  s_sub_u32 s30, s30, 1
  s_cmp_eq_u32 s30, 0
  s_cbranch_scc1 L2_loop_exit
  s_waitcnt lgkmcnt(0)
  v_pk_mul_f32 v[64:65], v[108:109], s[38:39]
  v_pk_mul_f32 v[66:67], v[110:111], s[38:39]
  v_pk_mul_f32 v[68:69], v[124:125], s[38:39]
  v_pk_mul_f32 v[70:71], v[126:127], s[38:39]
  v_exp_f32 v64, v64
  v_mfma_f32_32x32x16_bf16 v[72:87], v[28:31], v[44:47], v[72:87]
  v_exp_f32 v65, v65
  v_exp_f32 v66, v66
  v_exp_f32 v67, v67
  v_exp_f32 v68, v68
  v_exp_f32 v69, v69
  v_exp_f32 v70, v70
  v_exp_f32 v71, v71
  v_pk_add_f32 v[64:65], v[64:65], 1.0 op_sel_hi:[1,0]
  v_pk_add_f32 v[66:67], v[66:67], 1.0 op_sel_hi:[1,0]
  v_pk_add_f32 v[68:69], v[68:69], 1.0 op_sel_hi:[1,0]
  v_pk_add_f32 v[70:71], v[70:71], 1.0 op_sel_hi:[1,0]
  v_readlane_b32 s68, v15, 48
  v_readlane_b32 s69, v15, 52
  v_readlane_b32 s70, v15, 56
  v_readlane_b32 s71, v15, 60
  v_dot2_f32_bf16 v216, v19, v33, 0
  v_dot2_f32_bf16 v217, v19, v35, 0
  v_dot2_f32_bf16 v218, v19, v37, 0
  v_dot2_f32_bf16 v219, v19, v39, 0
  v_dot2_f32_bf16 v216, v18, v32, v216
  v_dot2_f32_bf16 v217, v18, v34, v217
  v_dot2_f32_bf16 v218, v18, v36, v218
  v_dot2_f32_bf16 v219, v18, v38, v219
  s_nop 2
  v_cvt_pk_bf16_f32 v22, v216, v217
  v_cvt_pk_bf16_f32 v23, v218, v219
  s_waitcnt vmcnt(4)
  v_mfma_f32_4x4x4_16b_bf16 v[216:219], v[20:21], v[200:201], 0 cbsz:4 abid:4
  v_rcp_f32 v64, v64
  v_mfma_f32_4x4x4_16b_bf16 v[220:223], v[20:21], v[202:203], 0 cbsz:4 abid:4
  v_rcp_f32 v65, v65
  v_mfma_f32_4x4x4_16b_bf16 v[224:227], v[20:21], v[204:205], 0 cbsz:4 abid:5
  v_rcp_f32 v66, v66
  v_mfma_f32_4x4x4_16b_bf16 v[228:231], v[20:21], v[206:207], 0 cbsz:4 abid:5
  v_rcp_f32 v67, v67
  v_mfma_f32_4x4x4_16b_bf16 v[232:235], v[20:21], v[208:209], 0 cbsz:4 abid:6
  v_rcp_f32 v68, v68
  v_mfma_f32_4x4x4_16b_bf16 v[236:239], v[20:21], v[210:211], 0 cbsz:4 abid:6
  v_rcp_f32 v69, v69
  v_mfma_f32_4x4x4_16b_bf16 v[240:243], v[20:21], v[212:213], 0 cbsz:4 abid:7
  v_rcp_f32 v70, v70
  v_mfma_f32_4x4x4_16b_bf16 v[244:247], v[20:21], v[214:215], 0 cbsz:4 abid:7
  v_rcp_f32 v71, v71
  s_andn2_b32 s72, s68, 63
  s_andn2_b32 s73, s69, 63
  s_andn2_b32 s74, s70, 63
  s_andn2_b32 s75, s71, 63
  buffer_load_dwordx4 v[200:203], v2, s[8:11], s72 offen
  buffer_load_dwordx4 v[204:207], v2, s[8:11], s73 offen
  buffer_load_dwordx4 v[208:211], v2, s[8:11], s74 offen
  buffer_load_dwordx4 v[212:215], v2, s[8:11], s75 offen
  v_pk_mul_f32 v[56:57], v[108:109], v[64:65]
  v_pk_mul_f32 v[58:59], v[110:111], v[66:67]
  v_pk_mul_f32 v[60:61], v[124:125], v[68:69]
  v_pk_mul_f32 v[62:63], v[126:127], v[70:71]
  s_set_gpr_idx_on s60, gpr_idx(SRC2,DST)
  v_pk_fma_f32 v[136:137], v[216:217], v[56:57], v[136:137] op_sel:[0,0,0] op_sel_hi:[1,0,1]
  v_pk_fma_f32 v[138:139], v[218:219], v[56:57], v[138:139] op_sel:[0,0,0] op_sel_hi:[1,0,1]
  v_pk_fma_f32 v[140:141], v[220:221], v[60:61], v[140:141] op_sel:[0,0,0] op_sel_hi:[1,0,1]
  v_pk_fma_f32 v[142:143], v[222:223], v[60:61], v[142:143] op_sel:[0,0,0] op_sel_hi:[1,0,1]
  s_set_gpr_idx_idx s61
  v_pk_fma_f32 v[136:137], v[224:225], v[56:57], v[136:137] op_sel:[0,1,0] op_sel_hi:[1,1,1]
  v_pk_fma_f32 v[138:139], v[226:227], v[56:57], v[138:139] op_sel:[0,1,0] op_sel_hi:[1,1,1]
  v_pk_fma_f32 v[140:141], v[228:229], v[60:61], v[140:141] op_sel:[0,1,0] op_sel_hi:[1,1,1]
  v_pk_fma_f32 v[142:143], v[230:231], v[60:61], v[142:143] op_sel:[0,1,0] op_sel_hi:[1,1,1]
  s_set_gpr_idx_idx s62
  v_pk_fma_f32 v[136:137], v[232:233], v[58:59], v[136:137] op_sel:[0,0,0] op_sel_hi:[1,0,1]
  v_pk_fma_f32 v[138:139], v[234:235], v[58:59], v[138:139] op_sel:[0,0,0] op_sel_hi:[1,0,1]
  v_pk_fma_f32 v[140:141], v[236:237], v[62:63], v[140:141] op_sel:[0,0,0] op_sel_hi:[1,0,1]
  v_pk_fma_f32 v[142:143], v[238:239], v[62:63], v[142:143] op_sel:[0,0,0] op_sel_hi:[1,0,1]
  s_set_gpr_idx_idx s63
  v_pk_fma_f32 v[136:137], v[240:241], v[58:59], v[136:137] op_sel:[0,1,0] op_sel_hi:[1,1,1]
  v_pk_fma_f32 v[138:139], v[242:243], v[58:59], v[138:139] op_sel:[0,1,0] op_sel_hi:[1,1,1]
  v_pk_fma_f32 v[140:141], v[244:245], v[62:63], v[140:141] op_sel:[0,1,0] op_sel_hi:[1,1,1]
  v_pk_fma_f32 v[142:143], v[246:247], v[62:63], v[142:143] op_sel:[0,1,0] op_sel_hi:[1,1,1]
  s_set_gpr_idx_off
  s_sub_u32 s30, s30, 1
  s_cmp_eq_u32 s30, 0
  s_cbranch_scc1 L2_loop_exit
  v_pk_mul_f32 v[64:65], v[112:113], s[38:39]
  v_pk_mul_f32 v[66:67], v[114:115], s[38:39]
  v_pk_mul_f32 v[68:69], v[128:129], s[38:39]
  v_pk_mul_f32 v[70:71], v[130:131], s[38:39]
  v_exp_f32 v64, v64
  v_mfma_f32_32x32x16_bf16 v[88:103], v[24:27], v[48:51], 0
  v_exp_f32 v65, v65
  v_exp_f32 v66, v66
  v_exp_f32 v67, v67
  v_exp_f32 v68, v68
  v_exp_f32 v69, v69
  v_exp_f32 v70, v70
  v_exp_f32 v71, v71
  v_pk_add_f32 v[64:65], v[64:65], 1.0 op_sel_hi:[1,0]
  v_pk_add_f32 v[66:67], v[66:67], 1.0 op_sel_hi:[1,0]
  v_pk_add_f32 v[68:69], v[68:69], 1.0 op_sel_hi:[1,0]
  v_pk_add_f32 v[70:71], v[70:71], 1.0 op_sel_hi:[1,0]
  v_readlane_b32 s56, v16, 0
  v_readlane_b32 s57, v16, 4
  v_readlane_b32 s58, v16, 8
  v_readlane_b32 s59, v16, 12
  s_waitcnt vmcnt(4)
  v_mfma_f32_4x4x4_16b_bf16 v[216:219], v[20:21], v[184:185], 0 cbsz:4 abid:8
  v_rcp_f32 v64, v64
  v_mfma_f32_4x4x4_16b_bf16 v[220:223], v[20:21], v[186:187], 0 cbsz:4 abid:8
  v_rcp_f32 v65, v65
  v_mfma_f32_4x4x4_16b_bf16 v[224:227], v[20:21], v[188:189], 0 cbsz:4 abid:9
  v_rcp_f32 v66, v66
  v_mfma_f32_4x4x4_16b_bf16 v[228:231], v[20:21], v[190:191], 0 cbsz:4 abid:9
  v_rcp_f32 v67, v67
  v_mfma_f32_4x4x4_16b_bf16 v[232:235], v[20:21], v[192:193], 0 cbsz:4 abid:10
  v_rcp_f32 v68, v68
  v_mfma_f32_4x4x4_16b_bf16 v[236:239], v[20:21], v[194:195], 0 cbsz:4 abid:10
  v_rcp_f32 v69, v69
  v_mfma_f32_4x4x4_16b_bf16 v[240:243], v[20:21], v[196:197], 0 cbsz:4 abid:11
  v_rcp_f32 v70, v70
  v_mfma_f32_4x4x4_16b_bf16 v[244:247], v[20:21], v[198:199], 0 cbsz:4 abid:11
  v_rcp_f32 v71, v71
  s_andn2_b32 s72, s56, 63
  s_andn2_b32 s73, s57, 63
  s_andn2_b32 s74, s58, 63
  s_andn2_b32 s75, s59, 63
  buffer_load_dwordx4 v[184:187], v2, s[8:11], s72 offen
  buffer_load_dwordx4 v[188:191], v2, s[8:11], s73 offen
  buffer_load_dwordx4 v[192:195], v2, s[8:11], s74 offen
  buffer_load_dwordx4 v[196:199], v2, s[8:11], s75 offen
  v_pk_mul_f32 v[56:57], v[112:113], v[64:65]
  v_pk_mul_f32 v[58:59], v[114:115], v[66:67]
  v_pk_mul_f32 v[60:61], v[128:129], v[68:69]
  v_pk_mul_f32 v[62:63], v[130:131], v[70:71]
  s_set_gpr_idx_on s64, gpr_idx(SRC2,DST)
  v_pk_fma_f32 v[136:137], v[216:217], v[56:57], v[136:137] op_sel:[0,0,0] op_sel_hi:[1,0,1]
  v_pk_fma_f32 v[138:139], v[218:219], v[56:57], v[138:139] op_sel:[0,0,0] op_sel_hi:[1,0,1]
  v_pk_fma_f32 v[140:141], v[220:221], v[60:61], v[140:141] op_sel:[0,0,0] op_sel_hi:[1,0,1]
  v_pk_fma_f32 v[142:143], v[222:223], v[60:61], v[142:143] op_sel:[0,0,0] op_sel_hi:[1,0,1]
  s_set_gpr_idx_idx s65
  v_pk_fma_f32 v[136:137], v[224:225], v[56:57], v[136:137] op_sel:[0,1,0] op_sel_hi:[1,1,1]
  v_pk_fma_f32 v[138:139], v[226:227], v[56:57], v[138:139] op_sel:[0,1,0] op_sel_hi:[1,1,1]
  v_pk_fma_f32 v[140:141], v[228:229], v[60:61], v[140:141] op_sel:[0,1,0] op_sel_hi:[1,1,1]
  v_pk_fma_f32 v[142:143], v[230:231], v[60:61], v[142:143] op_sel:[0,1,0] op_sel_hi:[1,1,1]
  s_set_gpr_idx_idx s66
  v_pk_fma_f32 v[136:137], v[232:233], v[58:59], v[136:137] op_sel:[0,0,0] op_sel_hi:[1,0,1]
  v_pk_fma_f32 v[138:139], v[234:235], v[58:59], v[138:139] op_sel:[0,0,0] op_sel_hi:[1,0,1]
  v_pk_fma_f32 v[140:141], v[236:237], v[62:63], v[140:141] op_sel:[0,0,0] op_sel_hi:[1,0,1]
  v_pk_fma_f32 v[142:143], v[238:239], v[62:63], v[142:143] op_sel:[0,0,0] op_sel_hi:[1,0,1]
  s_set_gpr_idx_idx s67
  v_pk_fma_f32 v[136:137], v[240:241], v[58:59], v[136:137] op_sel:[0,1,0] op_sel_hi:[1,1,1]
  v_pk_fma_f32 v[138:139], v[242:243], v[58:59], v[138:139] op_sel:[0,1,0] op_sel_hi:[1,1,1]
  v_pk_fma_f32 v[140:141], v[244:245], v[62:63], v[140:141] op_sel:[0,1,0] op_sel_hi:[1,1,1]
  v_pk_fma_f32 v[142:143], v[246:247], v[62:63], v[142:143] op_sel:[0,1,0] op_sel_hi:[1,1,1]
  s_set_gpr_idx_off
  s_sub_u32 s30, s30, 1
  s_cmp_eq_u32 s30, 0
  s_cbranch_scc1 L2_loop_exit
  v_pk_mul_f32 v[64:65], v[116:117], s[38:39]
  v_pk_mul_f32 v[66:67], v[118:119], s[38:39]
  v_pk_mul_f32 v[68:69], v[132:133], s[38:39]
  v_pk_mul_f32 v[70:71], v[134:135], s[38:39]
  v_exp_f32 v64, v64
  v_mfma_f32_32x32x16_bf16 v[88:103], v[28:31], v[52:55], v[88:103]
  v_exp_f32 v65, v65
  v_exp_f32 v66, v66
  v_exp_f32 v67, v67
  v_exp_f32 v68, v68
  v_exp_f32 v69, v69
  v_exp_f32 v70, v70
  v_exp_f32 v71, v71
  v_pk_add_f32 v[64:65], v[64:65], 1.0 op_sel_hi:[1,0]
  v_pk_add_f32 v[66:67], v[66:67], 1.0 op_sel_hi:[1,0]
  v_pk_add_f32 v[68:69], v[68:69], 1.0 op_sel_hi:[1,0]
  v_pk_add_f32 v[70:71], v[70:71], 1.0 op_sel_hi:[1,0]
  v_readlane_b32 s60, v16, 16
  v_readlane_b32 s61, v16, 20
  v_readlane_b32 s62, v16, 24
  v_readlane_b32 s63, v16, 28
  s_waitcnt vmcnt(4)
  ds_read_b128 v[24:27], v11
  ds_read_b128 v[28:31], v12
  v_add_u32 v11, v11, v13
  v_add_u32 v12, v12, v14
  v_mfma_f32_4x4x4_16b_bf16 v[216:219], v[20:21], v[200:201], 0 cbsz:4 abid:12
  v_rcp_f32 v64, v64
  v_mfma_f32_4x4x4_16b_bf16 v[220:223], v[20:21], v[202:203], 0 cbsz:4 abid:12
  v_rcp_f32 v65, v65
  v_mfma_f32_4x4x4_16b_bf16 v[224:227], v[20:21], v[204:205], 0 cbsz:4 abid:13
  v_rcp_f32 v66, v66
  v_mfma_f32_4x4x4_16b_bf16 v[228:231], v[20:21], v[206:207], 0 cbsz:4 abid:13
  v_rcp_f32 v67, v67
  v_mfma_f32_4x4x4_16b_bf16 v[232:235], v[20:21], v[208:209], 0 cbsz:4 abid:14
  v_rcp_f32 v68, v68
  v_mfma_f32_4x4x4_16b_bf16 v[236:239], v[20:21], v[210:211], 0 cbsz:4 abid:14
  v_rcp_f32 v69, v69
  v_mfma_f32_4x4x4_16b_bf16 v[240:243], v[20:21], v[212:213], 0 cbsz:4 abid:15
  v_rcp_f32 v70, v70
  v_mfma_f32_4x4x4_16b_bf16 v[244:247], v[20:21], v[214:215], 0 cbsz:4 abid:15
  v_rcp_f32 v71, v71
  s_andn2_b32 s72, s60, 63
  s_andn2_b32 s73, s61, 63
  s_andn2_b32 s74, s62, 63
  s_andn2_b32 s75, s63, 63
  buffer_load_dwordx4 v[200:203], v2, s[8:11], s72 offen
  buffer_load_dwordx4 v[204:207], v2, s[8:11], s73 offen
  buffer_load_dwordx4 v[208:211], v2, s[8:11], s74 offen
  buffer_load_dwordx4 v[212:215], v2, s[8:11], s75 offen
  v_pk_mul_f32 v[56:57], v[116:117], v[64:65]
  v_pk_mul_f32 v[58:59], v[118:119], v[66:67]
  v_pk_mul_f32 v[60:61], v[132:133], v[68:69]
  v_pk_mul_f32 v[62:63], v[134:135], v[70:71]
  s_set_gpr_idx_on s68, gpr_idx(SRC2,DST)
  v_pk_fma_f32 v[136:137], v[216:217], v[56:57], v[136:137] op_sel:[0,0,0] op_sel_hi:[1,0,1]
  v_pk_fma_f32 v[138:139], v[218:219], v[56:57], v[138:139] op_sel:[0,0,0] op_sel_hi:[1,0,1]
  v_pk_fma_f32 v[140:141], v[220:221], v[60:61], v[140:141] op_sel:[0,0,0] op_sel_hi:[1,0,1]
  v_pk_fma_f32 v[142:143], v[222:223], v[60:61], v[142:143] op_sel:[0,0,0] op_sel_hi:[1,0,1]
  s_set_gpr_idx_idx s69
  v_pk_fma_f32 v[136:137], v[224:225], v[56:57], v[136:137] op_sel:[0,1,0] op_sel_hi:[1,1,1]
  v_pk_fma_f32 v[138:139], v[226:227], v[56:57], v[138:139] op_sel:[0,1,0] op_sel_hi:[1,1,1]
  v_pk_fma_f32 v[140:141], v[228:229], v[60:61], v[140:141] op_sel:[0,1,0] op_sel_hi:[1,1,1]
  v_pk_fma_f32 v[142:143], v[230:231], v[60:61], v[142:143] op_sel:[0,1,0] op_sel_hi:[1,1,1]
  s_set_gpr_idx_idx s70
  v_pk_fma_f32 v[136:137], v[232:233], v[58:59], v[136:137] op_sel:[0,0,0] op_sel_hi:[1,0,1]
  v_pk_fma_f32 v[138:139], v[234:235], v[58:59], v[138:139] op_sel:[0,0,0] op_sel_hi:[1,0,1]
  v_pk_fma_f32 v[140:141], v[236:237], v[62:63], v[140:141] op_sel:[0,0,0] op_sel_hi:[1,0,1]
  v_pk_fma_f32 v[142:143], v[238:239], v[62:63], v[142:143] op_sel:[0,0,0] op_sel_hi:[1,0,1]
  s_set_gpr_idx_idx s71
  v_pk_fma_f32 v[136:137], v[240:241], v[58:59], v[136:137] op_sel:[0,1,0] op_sel_hi:[1,1,1]
  v_pk_fma_f32 v[138:139], v[242:243], v[58:59], v[138:139] op_sel:[0,1,0] op_sel_hi:[1,1,1]
  v_pk_fma_f32 v[140:141], v[244:245], v[62:63], v[140:141] op_sel:[0,1,0] op_sel_hi:[1,1,1]
  v_pk_fma_f32 v[142:143], v[246:247], v[62:63], v[142:143] op_sel:[0,1,0] op_sel_hi:[1,1,1]
  s_set_gpr_idx_off
  v_mov_b32 v20, v22
  v_mov_b32 v21, v23
  v_mov_b32 v15, v16
  v_add_u32 v10, 256, v10
  s_sub_u32 s30, s30, 1
  s_cmp_eq_u32 s30, 0
  s_cbranch_scc1 L2_loop_exit
  s_cmp_ge_u32 s28, 4
  s_cbranch_scc1 L2_pl_0_0_0
  s_setprio 1
  s_branch L2_ph_0_0_0
L2_pl_0_0_0:
  s_setprio 0
L2_ph_0_0_0:
  s_waitcnt lgkmcnt(0)
  ds_read_b128 v[16:19], v10
  v_pk_mul_f32 v[64:65], v[72:73], s[38:39]
  v_pk_mul_f32 v[66:67], v[74:75], s[38:39]
  v_pk_mul_f32 v[68:69], v[88:89], s[38:39]
  v_pk_mul_f32 v[70:71], v[90:91], s[38:39]
  v_exp_f32 v64, v64
  v_mfma_f32_32x32x16_bf16 v[104:119], v[24:27], v[40:43], 0
  v_exp_f32 v65, v65
  v_exp_f32 v66, v66
  v_exp_f32 v67, v67
  v_exp_f32 v68, v68
  v_exp_f32 v69, v69
  v_exp_f32 v70, v70
  v_exp_f32 v71, v71
  v_pk_add_f32 v[64:65], v[64:65], 1.0 op_sel_hi:[1,0]
  v_pk_add_f32 v[66:67], v[66:67], 1.0 op_sel_hi:[1,0]
  v_pk_add_f32 v[68:69], v[68:69], 1.0 op_sel_hi:[1,0]
  v_pk_add_f32 v[70:71], v[70:71], 1.0 op_sel_hi:[1,0]
  v_readlane_b32 s64, v15, 32
  v_readlane_b32 s65, v15, 36
  v_readlane_b32 s66, v15, 40
  v_readlane_b32 s67, v15, 44
  s_waitcnt vmcnt(4)
  v_mfma_f32_4x4x4_16b_bf16 v[216:219], v[20:21], v[184:185], 0 cbsz:4 abid:0
  v_rcp_f32 v64, v64
  v_mfma_f32_4x4x4_16b_bf16 v[220:223], v[20:21], v[186:187], 0 cbsz:4 abid:0
  v_rcp_f32 v65, v65
  v_mfma_f32_4x4x4_16b_bf16 v[224:227], v[20:21], v[188:189], 0 cbsz:4 abid:1
  v_rcp_f32 v66, v66
  v_mfma_f32_4x4x4_16b_bf16 v[228:231], v[20:21], v[190:191], 0 cbsz:4 abid:1
  v_rcp_f32 v67, v67
  v_mfma_f32_4x4x4_16b_bf16 v[232:235], v[20:21], v[192:193], 0 cbsz:4 abid:2
  v_rcp_f32 v68, v68
  v_mfma_f32_4x4x4_16b_bf16 v[236:239], v[20:21], v[194:195], 0 cbsz:4 abid:2
  v_rcp_f32 v69, v69
  v_mfma_f32_4x4x4_16b_bf16 v[240:243], v[20:21], v[196:197], 0 cbsz:4 abid:3
  v_rcp_f32 v70, v70
  v_mfma_f32_4x4x4_16b_bf16 v[244:247], v[20:21], v[198:199], 0 cbsz:4 abid:3
  v_rcp_f32 v71, v71
  s_andn2_b32 s72, s64, 63
  s_andn2_b32 s73, s65, 63
  s_andn2_b32 s74, s66, 63
  s_andn2_b32 s75, s67, 63
  buffer_load_dwordx4 v[184:187], v2, s[8:11], s72 offen
  buffer_load_dwordx4 v[188:191], v2, s[8:11], s73 offen
  buffer_load_dwordx4 v[192:195], v2, s[8:11], s74 offen
  buffer_load_dwordx4 v[196:199], v2, s[8:11], s75 offen
  v_pk_mul_f32 v[56:57], v[72:73], v[64:65]
  v_pk_mul_f32 v[58:59], v[74:75], v[66:67]
  v_pk_mul_f32 v[60:61], v[88:89], v[68:69]
  v_pk_mul_f32 v[62:63], v[90:91], v[70:71]
  s_set_gpr_idx_on s56, gpr_idx(SRC2,DST)
  v_pk_fma_f32 v[136:137], v[216:217], v[56:57], v[136:137] op_sel:[0,0,0] op_sel_hi:[1,0,1]
  v_pk_fma_f32 v[138:139], v[218:219], v[56:57], v[138:139] op_sel:[0,0,0] op_sel_hi:[1,0,1]
  v_pk_fma_f32 v[140:141], v[220:221], v[60:61], v[140:141] op_sel:[0,0,0] op_sel_hi:[1,0,1]
  v_pk_fma_f32 v[142:143], v[222:223], v[60:61], v[142:143] op_sel:[0,0,0] op_sel_hi:[1,0,1]
  s_set_gpr_idx_idx s57
  v_pk_fma_f32 v[136:137], v[224:225], v[56:57], v[136:137] op_sel:[0,1,0] op_sel_hi:[1,1,1]
  v_pk_fma_f32 v[138:139], v[226:227], v[56:57], v[138:139] op_sel:[0,1,0] op_sel_hi:[1,1,1]
  v_pk_fma_f32 v[140:141], v[228:229], v[60:61], v[140:141] op_sel:[0,1,0] op_sel_hi:[1,1,1]
  v_pk_fma_f32 v[142:143], v[230:231], v[60:61], v[142:143] op_sel:[0,1,0] op_sel_hi:[1,1,1]
  s_set_gpr_idx_idx s58
  v_pk_fma_f32 v[136:137], v[232:233], v[58:59], v[136:137] op_sel:[0,0,0] op_sel_hi:[1,0,1]
  v_pk_fma_f32 v[138:139], v[234:235], v[58:59], v[138:139] op_sel:[0,0,0] op_sel_hi:[1,0,1]
  v_pk_fma_f32 v[140:141], v[236:237], v[62:63], v[140:141] op_sel:[0,0,0] op_sel_hi:[1,0,1]
  v_pk_fma_f32 v[142:143], v[238:239], v[62:63], v[142:143] op_sel:[0,0,0] op_sel_hi:[1,0,1]
  s_set_gpr_idx_idx s59
  v_pk_fma_f32 v[136:137], v[240:241], v[58:59], v[136:137] op_sel:[0,1,0] op_sel_hi:[1,1,1]
  v_pk_fma_f32 v[138:139], v[242:243], v[58:59], v[138:139] op_sel:[0,1,0] op_sel_hi:[1,1,1]
  v_pk_fma_f32 v[140:141], v[244:245], v[62:63], v[140:141] op_sel:[0,1,0] op_sel_hi:[1,1,1]
  v_pk_fma_f32 v[142:143], v[246:247], v[62:63], v[142:143] op_sel:[0,1,0] op_sel_hi:[1,1,1]
  s_set_gpr_idx_off
  s_sub_u32 s30, s30, 1
  s_cmp_eq_u32 s30, 0
  s_cbranch_scc1 L2_loop_exit
  s_waitcnt lgkmcnt(0)
  v_pk_mul_f32 v[64:65], v[76:77], s[38:39]
  v_pk_mul_f32 v[66:67], v[78:79], s[38:39]
  v_pk_mul_f32 v[68:69], v[92:93], s[38:39]
  v_pk_mul_f32 v[70:71], v[94:95], s[38:39]
  v_exp_f32 v64, v64
  v_mfma_f32_32x32x16_bf16 v[104:119], v[28:31], v[44:47], v[104:119]
  v_exp_f32 v65, v65
  v_exp_f32 v66, v66
  v_exp_f32 v67, v67
  v_exp_f32 v68, v68
  v_exp_f32 v69, v69
  v_exp_f32 v70, v70
  v_exp_f32 v71, v71
  v_pk_add_f32 v[64:65], v[64:65], 1.0 op_sel_hi:[1,0]
  v_pk_add_f32 v[66:67], v[66:67], 1.0 op_sel_hi:[1,0]
  v_pk_add_f32 v[68:69], v[68:69], 1.0 op_sel_hi:[1,0]
  v_pk_add_f32 v[70:71], v[70:71], 1.0 op_sel_hi:[1,0]
  v_readlane_b32 s68, v15, 48
  v_readlane_b32 s69, v15, 52
  v_readlane_b32 s70, v15, 56
  v_readlane_b32 s71, v15, 60
  v_dot2_f32_bf16 v216, v19, v33, 0
  v_dot2_f32_bf16 v217, v19, v35, 0
  v_dot2_f32_bf16 v218, v19, v37, 0
  v_dot2_f32_bf16 v219, v19, v39, 0
  v_dot2_f32_bf16 v216, v18, v32, v216
  v_dot2_f32_bf16 v217, v18, v34, v217
  v_dot2_f32_bf16 v218, v18, v36, v218
  v_dot2_f32_bf16 v219, v18, v38, v219
  s_nop 2
  v_cvt_pk_bf16_f32 v22, v216, v217
  v_cvt_pk_bf16_f32 v23, v218, v219
  s_waitcnt vmcnt(4)
  v_mfma_f32_4x4x4_16b_bf16 v[216:219], v[20:21], v[200:201], 0 cbsz:4 abid:4
  v_rcp_f32 v64, v64
  v_mfma_f32_4x4x4_16b_bf16 v[220:223], v[20:21], v[202:203], 0 cbsz:4 abid:4
  v_rcp_f32 v65, v65
  v_mfma_f32_4x4x4_16b_bf16 v[224:227], v[20:21], v[204:205], 0 cbsz:4 abid:5
  v_rcp_f32 v66, v66
  v_mfma_f32_4x4x4_16b_bf16 v[228:231], v[20:21], v[206:207], 0 cbsz:4 abid:5
  v_rcp_f32 v67, v67
  v_mfma_f32_4x4x4_16b_bf16 v[232:235], v[20:21], v[208:209], 0 cbsz:4 abid:6
  v_rcp_f32 v68, v68
  v_mfma_f32_4x4x4_16b_bf16 v[236:239], v[20:21], v[210:211], 0 cbsz:4 abid:6
  v_rcp_f32 v69, v69
  v_mfma_f32_4x4x4_16b_bf16 v[240:243], v[20:21], v[212:213], 0 cbsz:4 abid:7
  v_rcp_f32 v70, v70
  v_mfma_f32_4x4x4_16b_bf16 v[244:247], v[20:21], v[214:215], 0 cbsz:4 abid:7
  v_rcp_f32 v71, v71
  s_andn2_b32 s72, s68, 63
  s_andn2_b32 s73, s69, 63
  s_andn2_b32 s74, s70, 63
  s_andn2_b32 s75, s71, 63
  buffer_load_dwordx4 v[200:203], v2, s[8:11], s72 offen
  buffer_load_dwordx4 v[204:207], v2, s[8:11], s73 offen
  buffer_load_dwordx4 v[208:211], v2, s[8:11], s74 offen
  buffer_load_dwordx4 v[212:215], v2, s[8:11], s75 offen
  v_pk_mul_f32 v[56:57], v[76:77], v[64:65]
  v_pk_mul_f32 v[58:59], v[78:79], v[66:67]
  v_pk_mul_f32 v[60:61], v[92:93], v[68:69]
  v_pk_mul_f32 v[62:63], v[94:95], v[70:71]
  s_set_gpr_idx_on s60, gpr_idx(SRC2,DST)
  v_pk_fma_f32 v[136:137], v[216:217], v[56:57], v[136:137] op_sel:[0,0,0] op_sel_hi:[1,0,1]
  v_pk_fma_f32 v[138:139], v[218:219], v[56:57], v[138:139] op_sel:[0,0,0] op_sel_hi:[1,0,1]
  v_pk_fma_f32 v[140:141], v[220:221], v[60:61], v[140:141] op_sel:[0,0,0] op_sel_hi:[1,0,1]
  v_pk_fma_f32 v[142:143], v[222:223], v[60:61], v[142:143] op_sel:[0,0,0] op_sel_hi:[1,0,1]
  s_set_gpr_idx_idx s61
  v_pk_fma_f32 v[136:137], v[224:225], v[56:57], v[136:137] op_sel:[0,1,0] op_sel_hi:[1,1,1]
  v_pk_fma_f32 v[138:139], v[226:227], v[56:57], v[138:139] op_sel:[0,1,0] op_sel_hi:[1,1,1]
  v_pk_fma_f32 v[140:141], v[228:229], v[60:61], v[140:141] op_sel:[0,1,0] op_sel_hi:[1,1,1]
  v_pk_fma_f32 v[142:143], v[230:231], v[60:61], v[142:143] op_sel:[0,1,0] op_sel_hi:[1,1,1]
  s_set_gpr_idx_idx s62
  v_pk_fma_f32 v[136:137], v[232:233], v[58:59], v[136:137] op_sel:[0,0,0] op_sel_hi:[1,0,1]
  v_pk_fma_f32 v[138:139], v[234:235], v[58:59], v[138:139] op_sel:[0,0,0] op_sel_hi:[1,0,1]
  v_pk_fma_f32 v[140:141], v[236:237], v[62:63], v[140:141] op_sel:[0,0,0] op_sel_hi:[1,0,1]
  v_pk_fma_f32 v[142:143], v[238:239], v[62:63], v[142:143] op_sel:[0,0,0] op_sel_hi:[1,0,1]
  s_set_gpr_idx_idx s63
  v_pk_fma_f32 v[136:137], v[240:241], v[58:59], v[136:137] op_sel:[0,1,0] op_sel_hi:[1,1,1]
  v_pk_fma_f32 v[138:139], v[242:243], v[58:59], v[138:139] op_sel:[0,1,0] op_sel_hi:[1,1,1]
  v_pk_fma_f32 v[140:141], v[244:245], v[62:63], v[140:141] op_sel:[0,1,0] op_sel_hi:[1,1,1]
  v_pk_fma_f32 v[142:143], v[246:247], v[62:63], v[142:143] op_sel:[0,1,0] op_sel_hi:[1,1,1]
  s_set_gpr_idx_off
  s_sub_u32 s30, s30, 1
  s_cmp_eq_u32 s30, 0
  s_cbranch_scc1 L2_loop_exit
  v_pk_mul_f32 v[64:65], v[80:81], s[38:39]
  v_pk_mul_f32 v[66:67], v[82:83], s[38:39]
  v_pk_mul_f32 v[68:69], v[96:97], s[38:39]
  v_pk_mul_f32 v[70:71], v[98:99], s[38:39]
  v_exp_f32 v64, v64
  v_mfma_f32_32x32x16_bf16 v[120:135], v[24:27], v[48:51], 0
  v_exp_f32 v65, v65
  v_exp_f32 v66, v66
  v_exp_f32 v67, v67
  v_exp_f32 v68, v68
  v_exp_f32 v69, v69
  v_exp_f32 v70, v70
  v_exp_f32 v71, v71
  v_pk_add_f32 v[64:65], v[64:65], 1.0 op_sel_hi:[1,0]
  v_pk_add_f32 v[66:67], v[66:67], 1.0 op_sel_hi:[1,0]
  v_pk_add_f32 v[68:69], v[68:69], 1.0 op_sel_hi:[1,0]
  v_pk_add_f32 v[70:71], v[70:71], 1.0 op_sel_hi:[1,0]
  v_readlane_b32 s56, v16, 0
  v_readlane_b32 s57, v16, 4
  v_readlane_b32 s58, v16, 8
  v_readlane_b32 s59, v16, 12
  s_waitcnt vmcnt(4)
  v_mfma_f32_4x4x4_16b_bf16 v[216:219], v[20:21], v[184:185], 0 cbsz:4 abid:8
  v_rcp_f32 v64, v64
  v_mfma_f32_4x4x4_16b_bf16 v[220:223], v[20:21], v[186:187], 0 cbsz:4 abid:8
  v_rcp_f32 v65, v65
  v_mfma_f32_4x4x4_16b_bf16 v[224:227], v[20:21], v[188:189], 0 cbsz:4 abid:9
  v_rcp_f32 v66, v66
  v_mfma_f32_4x4x4_16b_bf16 v[228:231], v[20:21], v[190:191], 0 cbsz:4 abid:9
  v_rcp_f32 v67, v67
  v_mfma_f32_4x4x4_16b_bf16 v[232:235], v[20:21], v[192:193], 0 cbsz:4 abid:10
  v_rcp_f32 v68, v68
  v_mfma_f32_4x4x4_16b_bf16 v[236:239], v[20:21], v[194:195], 0 cbsz:4 abid:10
  v_rcp_f32 v69, v69
  v_mfma_f32_4x4x4_16b_bf16 v[240:243], v[20:21], v[196:197], 0 cbsz:4 abid:11
  v_rcp_f32 v70, v70
  v_mfma_f32_4x4x4_16b_bf16 v[244:247], v[20:21], v[198:199], 0 cbsz:4 abid:11
  v_rcp_f32 v71, v71
  s_andn2_b32 s72, s56, 63
  s_andn2_b32 s73, s57, 63
  s_andn2_b32 s74, s58, 63
  s_andn2_b32 s75, s59, 63
  buffer_load_dwordx4 v[184:187], v2, s[8:11], s72 offen
  buffer_load_dwordx4 v[188:191], v2, s[8:11], s73 offen
  buffer_load_dwordx4 v[192:195], v2, s[8:11], s74 offen
  buffer_load_dwordx4 v[196:199], v2, s[8:11], s75 offen
  v_pk_mul_f32 v[56:57], v[80:81], v[64:65]
  v_pk_mul_f32 v[58:59], v[82:83], v[66:67]
  v_pk_mul_f32 v[60:61], v[96:97], v[68:69]
  v_pk_mul_f32 v[62:63], v[98:99], v[70:71]
  s_set_gpr_idx_on s64, gpr_idx(SRC2,DST)
  v_pk_fma_f32 v[136:137], v[216:217], v[56:57], v[136:137] op_sel:[0,0,0] op_sel_hi:[1,0,1]
  v_pk_fma_f32 v[138:139], v[218:219], v[56:57], v[138:139] op_sel:[0,0,0] op_sel_hi:[1,0,1]
  v_pk_fma_f32 v[140:141], v[220:221], v[60:61], v[140:141] op_sel:[0,0,0] op_sel_hi:[1,0,1]
  v_pk_fma_f32 v[142:143], v[222:223], v[60:61], v[142:143] op_sel:[0,0,0] op_sel_hi:[1,0,1]
  s_set_gpr_idx_idx s65
  v_pk_fma_f32 v[136:137], v[224:225], v[56:57], v[136:137] op_sel:[0,1,0] op_sel_hi:[1,1,1]
  v_pk_fma_f32 v[138:139], v[226:227], v[56:57], v[138:139] op_sel:[0,1,0] op_sel_hi:[1,1,1]
  v_pk_fma_f32 v[140:141], v[228:229], v[60:61], v[140:141] op_sel:[0,1,0] op_sel_hi:[1,1,1]
  v_pk_fma_f32 v[142:143], v[230:231], v[60:61], v[142:143] op_sel:[0,1,0] op_sel_hi:[1,1,1]
  s_set_gpr_idx_idx s66
  v_pk_fma_f32 v[136:137], v[232:233], v[58:59], v[136:137] op_sel:[0,0,0] op_sel_hi:[1,0,1]
  v_pk_fma_f32 v[138:139], v[234:235], v[58:59], v[138:139] op_sel:[0,0,0] op_sel_hi:[1,0,1]
  v_pk_fma_f32 v[140:141], v[236:237], v[62:63], v[140:141] op_sel:[0,0,0] op_sel_hi:[1,0,1]
  v_pk_fma_f32 v[142:143], v[238:239], v[62:63], v[142:143] op_sel:[0,0,0] op_sel_hi:[1,0,1]
  s_set_gpr_idx_idx s67
  v_pk_fma_f32 v[136:137], v[240:241], v[58:59], v[136:137] op_sel:[0,1,0] op_sel_hi:[1,1,1]
  v_pk_fma_f32 v[138:139], v[242:243], v[58:59], v[138:139] op_sel:[0,1,0] op_sel_hi:[1,1,1]
  v_pk_fma_f32 v[140:141], v[244:245], v[62:63], v[140:141] op_sel:[0,1,0] op_sel_hi:[1,1,1]
  v_pk_fma_f32 v[142:143], v[246:247], v[62:63], v[142:143] op_sel:[0,1,0] op_sel_hi:[1,1,1]
  s_set_gpr_idx_off
  s_sub_u32 s30, s30, 1
  s_cmp_eq_u32 s30, 0
  s_cbranch_scc1 L2_loop_exit
  v_pk_mul_f32 v[64:65], v[84:85], s[38:39]
  v_pk_mul_f32 v[66:67], v[86:87], s[38:39]
  v_pk_mul_f32 v[68:69], v[100:101], s[38:39]
  v_pk_mul_f32 v[70:71], v[102:103], s[38:39]
  v_exp_f32 v64, v64
  v_mfma_f32_32x32x16_bf16 v[120:135], v[28:31], v[52:55], v[120:135]
  v_exp_f32 v65, v65
  v_exp_f32 v66, v66
  v_exp_f32 v67, v67
  v_exp_f32 v68, v68
  v_exp_f32 v69, v69
  v_exp_f32 v70, v70
  v_exp_f32 v71, v71
  v_pk_add_f32 v[64:65], v[64:65], 1.0 op_sel_hi:[1,0]
  v_pk_add_f32 v[66:67], v[66:67], 1.0 op_sel_hi:[1,0]
  v_pk_add_f32 v[68:69], v[68:69], 1.0 op_sel_hi:[1,0]
  v_pk_add_f32 v[70:71], v[70:71], 1.0 op_sel_hi:[1,0]
  v_readlane_b32 s60, v16, 16
  v_readlane_b32 s61, v16, 20
  v_readlane_b32 s62, v16, 24
  v_readlane_b32 s63, v16, 28
  s_waitcnt vmcnt(4)
  ds_read_b128 v[24:27], v11
  ds_read_b128 v[28:31], v12
  v_add_u32 v11, v11, v13
  v_add_u32 v12, v12, v14
  v_mfma_f32_4x4x4_16b_bf16 v[216:219], v[20:21], v[200:201], 0 cbsz:4 abid:12
  v_rcp_f32 v64, v64
  v_mfma_f32_4x4x4_16b_bf16 v[220:223], v[20:21], v[202:203], 0 cbsz:4 abid:12
  v_rcp_f32 v65, v65
  v_mfma_f32_4x4x4_16b_bf16 v[224:227], v[20:21], v[204:205], 0 cbsz:4 abid:13
  v_rcp_f32 v66, v66
  v_mfma_f32_4x4x4_16b_bf16 v[228:231], v[20:21], v[206:207], 0 cbsz:4 abid:13
  v_rcp_f32 v67, v67
  v_mfma_f32_4x4x4_16b_bf16 v[232:235], v[20:21], v[208:209], 0 cbsz:4 abid:14
  v_rcp_f32 v68, v68
  v_mfma_f32_4x4x4_16b_bf16 v[236:239], v[20:21], v[210:211], 0 cbsz:4 abid:14
  v_rcp_f32 v69, v69
  v_mfma_f32_4x4x4_16b_bf16 v[240:243], v[20:21], v[212:213], 0 cbsz:4 abid:15
  v_rcp_f32 v70, v70
  v_mfma_f32_4x4x4_16b_bf16 v[244:247], v[20:21], v[214:215], 0 cbsz:4 abid:15
  v_rcp_f32 v71, v71
  s_andn2_b32 s72, s60, 63
  s_andn2_b32 s73, s61, 63
  s_andn2_b32 s74, s62, 63
  s_andn2_b32 s75, s63, 63
  buffer_load_dwordx4 v[200:203], v2, s[8:11], s72 offen
  buffer_load_dwordx4 v[204:207], v2, s[8:11], s73 offen
  buffer_load_dwordx4 v[208:211], v2, s[8:11], s74 offen
  buffer_load_dwordx4 v[212:215], v2, s[8:11], s75 offen
  v_pk_mul_f32 v[56:57], v[84:85], v[64:65]
  v_pk_mul_f32 v[58:59], v[86:87], v[66:67]
  v_pk_mul_f32 v[60:61], v[100:101], v[68:69]
  v_pk_mul_f32 v[62:63], v[102:103], v[70:71]
  s_set_gpr_idx_on s68, gpr_idx(SRC2,DST)
  v_pk_fma_f32 v[136:137], v[216:217], v[56:57], v[136:137] op_sel:[0,0,0] op_sel_hi:[1,0,1]
  v_pk_fma_f32 v[138:139], v[218:219], v[56:57], v[138:139] op_sel:[0,0,0] op_sel_hi:[1,0,1]
  v_pk_fma_f32 v[140:141], v[220:221], v[60:61], v[140:141] op_sel:[0,0,0] op_sel_hi:[1,0,1]
  v_pk_fma_f32 v[142:143], v[222:223], v[60:61], v[142:143] op_sel:[0,0,0] op_sel_hi:[1,0,1]
  s_set_gpr_idx_idx s69
  v_pk_fma_f32 v[136:137], v[224:225], v[56:57], v[136:137] op_sel:[0,1,0] op_sel_hi:[1,1,1]
  v_pk_fma_f32 v[138:139], v[226:227], v[56:57], v[138:139] op_sel:[0,1,0] op_sel_hi:[1,1,1]
  v_pk_fma_f32 v[140:141], v[228:229], v[60:61], v[140:141] op_sel:[0,1,0] op_sel_hi:[1,1,1]
  v_pk_fma_f32 v[142:143], v[230:231], v[60:61], v[142:143] op_sel:[0,1,0] op_sel_hi:[1,1,1]
  s_set_gpr_idx_idx s70
  v_pk_fma_f32 v[136:137], v[232:233], v[58:59], v[136:137] op_sel:[0,0,0] op_sel_hi:[1,0,1]
  v_pk_fma_f32 v[138:139], v[234:235], v[58:59], v[138:139] op_sel:[0,0,0] op_sel_hi:[1,0,1]
  v_pk_fma_f32 v[140:141], v[236:237], v[62:63], v[140:141] op_sel:[0,0,0] op_sel_hi:[1,0,1]
  v_pk_fma_f32 v[142:143], v[238:239], v[62:63], v[142:143] op_sel:[0,0,0] op_sel_hi:[1,0,1]
  s_set_gpr_idx_idx s71
  v_pk_fma_f32 v[136:137], v[240:241], v[58:59], v[136:137] op_sel:[0,1,0] op_sel_hi:[1,1,1]
  v_pk_fma_f32 v[138:139], v[242:243], v[58:59], v[138:139] op_sel:[0,1,0] op_sel_hi:[1,1,1]
  v_pk_fma_f32 v[140:141], v[244:245], v[62:63], v[140:141] op_sel:[0,1,0] op_sel_hi:[1,1,1]
  v_pk_fma_f32 v[142:143], v[246:247], v[62:63], v[142:143] op_sel:[0,1,0] op_sel_hi:[1,1,1]
  s_set_gpr_idx_off
  v_mov_b32 v20, v22
  v_mov_b32 v21, v23
  v_mov_b32 v15, v16
  v_add_u32 v10, 256, v10
  s_sub_u32 s30, s30, 1
  s_cmp_eq_u32 s30, 0
  s_cbranch_scc0 L2_batch1
L2_loop_exit:
  s_waitcnt vmcnt(0) lgkmcnt(0)
  s_add_u32 s31, s31, s32
  s_cmp_lt_u32 s31, s33
  s_cbranch_scc0 L2_epilogue
L2_rezero:
  s_barrier
  v_lshlrev_b32 v4, 2, v0
  v_mov_b32 v5, 0
  ds_write_b32 v4, v5 offset:0
  v_mov_b32 v4, 2048
  ds_write_b32 v4, v5
  v_mov_b32 v4, 2052
  ds_max_u32 v4, v7
  s_waitcnt lgkmcnt(0)
  s_barrier
  s_branch L2_pass
L2_overflow:
  s_mov_b32 s32, 1
  s_branch L2_rezero
L2_epilogue:
  ds_read_b64_tr_b16 v[184:185], v250 offset:0
  ds_read_b64_tr_b16 v[186:187], v250 offset:4096
  ds_read_b64_tr_b16 v[188:189], v250 offset:8192
  ds_read_b64_tr_b16 v[190:191], v250 offset:12288
  ds_read_b64_tr_b16 v[192:193], v250 offset:16384
  ds_read_b64_tr_b16 v[194:195], v250 offset:20480
  ds_read_b64_tr_b16 v[196:197], v250 offset:24576
  ds_read_b64_tr_b16 v[198:199], v250 offset:28672
  v_xor_b32 v15, 32, v250
  ds_read_b64_tr_b16 v[200:201], v15 offset:0
  ds_read_b64_tr_b16 v[202:203], v15 offset:4096
  ds_read_b64_tr_b16 v[204:205], v15 offset:8192
  ds_read_b64_tr_b16 v[206:207], v15 offset:12288
  ds_read_b64_tr_b16 v[208:209], v15 offset:16384
  ds_read_b64_tr_b16 v[210:211], v15 offset:20480
  ds_read_b64_tr_b16 v[212:213], v15 offset:24576
  ds_read_b64_tr_b16 v[214:215], v15 offset:28672
  v_add_u32 v3, s16, v2
  v_cvt_pk_bf16_f32 v72, v136, v137
  v_cvt_pk_bf16_f32 v73, v138, v139
  v_cvt_pk_bf16_f32 v74, v140, v141
  v_cvt_pk_bf16_f32 v75, v142, v143
  ds_write_b128 v3, v[72:75] offset:0
  v_cvt_pk_bf16_f32 v76, v144, v145
  v_cvt_pk_bf16_f32 v77, v146, v147
  v_cvt_pk_bf16_f32 v78, v148, v149
  v_cvt_pk_bf16_f32 v79, v150, v151
  ds_write_b128 v3, v[76:79] offset:1088
  v_cvt_pk_bf16_f32 v80, v152, v153
  v_cvt_pk_bf16_f32 v81, v154, v155
  v_cvt_pk_bf16_f32 v82, v156, v157
  v_cvt_pk_bf16_f32 v83, v158, v159
  ds_write_b128 v3, v[80:83] offset:2176
  v_cvt_pk_bf16_f32 v84, v160, v161
  v_cvt_pk_bf16_f32 v85, v162, v163
  v_cvt_pk_bf16_f32 v86, v164, v165
  v_cvt_pk_bf16_f32 v87, v166, v167
  ds_write_b128 v3, v[84:87] offset:3264
  v_cvt_pk_bf16_f32 v88, v168, v169
  v_cvt_pk_bf16_f32 v89, v170, v171
  v_cvt_pk_bf16_f32 v90, v172, v173
  v_cvt_pk_bf16_f32 v91, v174, v175
  ds_write_b128 v3, v[88:91] offset:4352
  s_waitcnt lgkmcnt(0)
  s_barrier
  ds_read_b64_tr_b16 v[216:217], v248 offset:0
  ds_read_b64_tr_b16 v[218:219], v248 offset:128
  ds_read_b64_tr_b16 v[220:221], v248 offset:256
  ds_read_b64_tr_b16 v[222:223], v248 offset:384
  ds_read_b64_tr_b16 v[224:225], v248 offset:512
  ds_read_b64_tr_b16 v[226:227], v248 offset:640
  ds_read_b64_tr_b16 v[228:229], v248 offset:768
  ds_read_b64_tr_b16 v[230:231], v248 offset:896
  ds_read_b64_tr_b16 v[232:233], v248 offset:9216
  ds_read_b64_tr_b16 v[234:235], v248 offset:9344
  ds_read_b64_tr_b16 v[236:237], v248 offset:9472
  ds_read_b64_tr_b16 v[238:239], v248 offset:9600
  ds_read_b64_tr_b16 v[240:241], v248 offset:9728
  ds_read_b64_tr_b16 v[242:243], v248 offset:9856
  ds_read_b64_tr_b16 v[244:245], v248 offset:9984
  ds_read_b64_tr_b16 v[246:247], v248 offset:10112
  s_waitcnt lgkmcnt(8)
  v_mfma_f32_16x16x32_bf16 v[136:139], v[216:219], v[184:187], 0
  v_mfma_f32_16x16x32_bf16 v[136:139], v[220:223], v[188:191], v[136:139]
  v_mfma_f32_16x16x32_bf16 v[136:139], v[224:227], v[192:195], v[136:139]
  v_mfma_f32_16x16x32_bf16 v[136:139], v[228:231], v[196:199], v[136:139]
  v_mfma_f32_16x16x32_bf16 v[140:143], v[216:219], v[200:203], 0
  v_mfma_f32_16x16x32_bf16 v[140:143], v[220:223], v[204:207], v[140:143]
  v_mfma_f32_16x16x32_bf16 v[140:143], v[224:227], v[208:211], v[140:143]
  v_mfma_f32_16x16x32_bf16 v[140:143], v[228:231], v[212:215], v[140:143]
  ds_read_b64_tr_b16 v[216:217], v248 offset:18432
  ds_read_b64_tr_b16 v[218:219], v248 offset:18560
  ds_read_b64_tr_b16 v[220:221], v248 offset:18688
  ds_read_b64_tr_b16 v[222:223], v248 offset:18816
  ds_read_b64_tr_b16 v[224:225], v248 offset:18944
  ds_read_b64_tr_b16 v[226:227], v248 offset:19072
  ds_read_b64_tr_b16 v[228:229], v248 offset:19200
  ds_read_b64_tr_b16 v[230:231], v248 offset:19328
  s_waitcnt lgkmcnt(8)
  v_mfma_f32_16x16x32_bf16 v[144:147], v[232:235], v[184:187], 0
  v_mfma_f32_16x16x32_bf16 v[144:147], v[236:239], v[188:191], v[144:147]
  v_mfma_f32_16x16x32_bf16 v[144:147], v[240:243], v[192:195], v[144:147]
  v_mfma_f32_16x16x32_bf16 v[144:147], v[244:247], v[196:199], v[144:147]
  v_mfma_f32_16x16x32_bf16 v[148:151], v[232:235], v[200:203], 0
  v_mfma_f32_16x16x32_bf16 v[148:151], v[236:239], v[204:207], v[148:151]
  v_mfma_f32_16x16x32_bf16 v[148:151], v[240:243], v[208:211], v[148:151]
  v_mfma_f32_16x16x32_bf16 v[148:151], v[244:247], v[212:215], v[148:151]
  ds_read_b64_tr_b16 v[232:233], v248 offset:27648
  ds_read_b64_tr_b16 v[234:235], v248 offset:27776
  ds_read_b64_tr_b16 v[236:237], v248 offset:27904
  ds_read_b64_tr_b16 v[238:239], v248 offset:28032
  ds_read_b64_tr_b16 v[240:241], v248 offset:28160
  ds_read_b64_tr_b16 v[242:243], v248 offset:28288
  ds_read_b64_tr_b16 v[244:245], v248 offset:28416
  ds_read_b64_tr_b16 v[246:247], v248 offset:28544
  v_cvt_pk_bf16_f32 v64, v136, v137
  v_cvt_pk_bf16_f32 v65, v138, v139
  v_cvt_pk_bf16_f32 v66, v140, v141
  v_cvt_pk_bf16_f32 v67, v142, v143
  s_mov_b64 exec, s[88:89]
  buffer_store_dwordx4 v[64:67], v251, s[20:23], s98 offen sc1
  s_mov_b64 exec, -1
  s_waitcnt lgkmcnt(8)
  v_mfma_f32_16x16x32_bf16 v[136:139], v[216:219], v[184:187], 0
  v_mfma_f32_16x16x32_bf16 v[136:139], v[220:223], v[188:191], v[136:139]
  v_mfma_f32_16x16x32_bf16 v[136:139], v[224:227], v[192:195], v[136:139]
  v_mfma_f32_16x16x32_bf16 v[136:139], v[228:231], v[196:199], v[136:139]
  v_mfma_f32_16x16x32_bf16 v[140:143], v[216:219], v[200:203], 0
  v_mfma_f32_16x16x32_bf16 v[140:143], v[220:223], v[204:207], v[140:143]
  v_mfma_f32_16x16x32_bf16 v[140:143], v[224:227], v[208:211], v[140:143]
  v_mfma_f32_16x16x32_bf16 v[140:143], v[228:231], v[212:215], v[140:143]
  ds_read_b64_tr_b16 v[216:217], v249 offset:0
  ds_read_b64_tr_b16 v[218:219], v249 offset:128
  ds_read_b64_tr_b16 v[220:221], v249 offset:256
  ds_read_b64_tr_b16 v[222:223], v249 offset:384
  ds_read_b64_tr_b16 v[224:225], v249 offset:512
  ds_read_b64_tr_b16 v[226:227], v249 offset:640
  ds_read_b64_tr_b16 v[228:229], v249 offset:768
  ds_read_b64_tr_b16 v[230:231], v249 offset:896
  v_cvt_pk_bf16_f32 v68, v144, v145
  v_cvt_pk_bf16_f32 v69, v146, v147
  v_cvt_pk_bf16_f32 v70, v148, v149
  v_cvt_pk_bf16_f32 v71, v150, v151
  s_mov_b64 exec, s[90:91]
  buffer_store_dwordx4 v[68:71], v252, s[20:23], s98 offen sc1
  s_mov_b64 exec, -1
  s_waitcnt lgkmcnt(8)
  v_mfma_f32_16x16x32_bf16 v[144:147], v[232:235], v[184:187], 0
  v_mfma_f32_16x16x32_bf16 v[144:147], v[236:239], v[188:191], v[144:147]
  v_mfma_f32_16x16x32_bf16 v[144:147], v[240:243], v[192:195], v[144:147]
  v_mfma_f32_16x16x32_bf16 v[144:147], v[244:247], v[196:199], v[144:147]
  v_mfma_f32_16x16x32_bf16 v[148:151], v[232:235], v[200:203], 0
  v_mfma_f32_16x16x32_bf16 v[148:151], v[236:239], v[204:207], v[148:151]
  v_mfma_f32_16x16x32_bf16 v[148:151], v[240:243], v[208:211], v[148:151]
  v_mfma_f32_16x16x32_bf16 v[148:151], v[244:247], v[212:215], v[148:151]
  v_cvt_pk_bf16_f32 v64, v136, v137
  v_cvt_pk_bf16_f32 v65, v138, v139
  v_cvt_pk_bf16_f32 v66, v140, v141
  v_cvt_pk_bf16_f32 v67, v142, v143
  s_mov_b64 exec, s[92:93]
  buffer_store_dwordx4 v[64:67], v253, s[20:23], s98 offen sc1
  s_mov_b64 exec, -1
  s_waitcnt lgkmcnt(0)
  v_mfma_f32_16x16x32_bf16 v[136:139], v[216:219], v[184:187], 0
  v_mfma_f32_16x16x32_bf16 v[136:139], v[220:223], v[188:191], v[136:139]
  v_mfma_f32_16x16x32_bf16 v[136:139], v[224:227], v[192:195], v[136:139]
  v_mfma_f32_16x16x32_bf16 v[136:139], v[228:231], v[196:199], v[136:139]
  v_mfma_f32_16x16x32_bf16 v[140:143], v[216:219], v[200:203], 0
  v_mfma_f32_16x16x32_bf16 v[140:143], v[220:223], v[204:207], v[140:143]
  v_mfma_f32_16x16x32_bf16 v[140:143], v[224:227], v[208:211], v[140:143]
  v_mfma_f32_16x16x32_bf16 v[140:143], v[228:231], v[212:215], v[140:143]
  v_cvt_pk_bf16_f32 v68, v144, v145
  v_cvt_pk_bf16_f32 v69, v146, v147
  v_cvt_pk_bf16_f32 v70, v148, v149
  v_cvt_pk_bf16_f32 v71, v150, v151
  s_mov_b64 exec, s[94:95]
  buffer_store_dwordx4 v[68:71], v254, s[20:23], s98 offen sc1
  s_mov_b64 exec, -1
  s_nop 7
  v_cvt_pk_bf16_f32 v64, v136, v137
  v_cvt_pk_bf16_f32 v65, v138, v139
  v_cvt_pk_bf16_f32 v66, v140, v141
  v_cvt_pk_bf16_f32 v67, v142, v143
  s_mov_b64 exec, s[96:97]
  buffer_store_dwordx4 v[64:67], v255, s[20:23], s98 offen sc1
  s_mov_b64 exec, -1
L2_end:
  s_endpgm
L2_text_end:
.section .rodata,"a"
.p2align 6
.amdhsa_kernel bin_edges_kernel
  .amdhsa_next_free_vgpr 56
  .amdhsa_next_free_sgpr 64
  .amdhsa_accum_offset 56
  .amdhsa_group_segment_fixed_size 0
  .amdhsa_kernarg_size 88
  .amdhsa_user_sgpr_count 2
  .amdhsa_user_sgpr_kernarg_segment_ptr 1
  .amdhsa_system_sgpr_workgroup_id_x 1
  .amdhsa_float_denorm_mode_32 3
.end_amdhsa_kernel
.p2align 6
.amdhsa_kernel gather_scatter__tensor_product_equiv_tfn__graph_kernel
  .amdhsa_next_free_vgpr 256
  .amdhsa_next_free_sgpr 102
  .amdhsa_accum_offset 256
  .amdhsa_group_segment_fixed_size 0
  .amdhsa_kernarg_size 88
  .amdhsa_user_sgpr_count 2
  .amdhsa_user_sgpr_kernarg_segment_ptr 1
  .amdhsa_system_sgpr_workgroup_id_x 1
  .amdhsa_float_denorm_mode_32 3
.end_amdhsa_kernel
```
